```python
import torch

def _softmax(x, axis=-1):
    return torch.softmax(x, dim=axis)
def _gelu(x):
    return torch.nn.functional.gelu(x, approximate="tanh")
def _silu(x):
    return torch.nn.functional.silu(x)
def _sigmoid(x):
    return torch.sigmoid(x)
def _layernorm(x, axis=-1, eps=1e-5):
    m = x.mean(dim=axis, keepdim=True)
    v = x.var(dim=axis, keepdim=True, unbiased=False)
    return (x - m) / torch.sqrt(v + eps)
def _scatter_add(tgt, idx, src, axis=0):
    return tgt.clone().index_add_(axis, idx, src)
def _segment_sum(src, seg, n):
    out = torch.zeros((n,) + src.shape[1:], dtype=src.dtype)
    return out.index_add_(0, seg, src)
def _pad(x, pw):
    flat = tuple(v for pair in reversed(pw) for v in pair)
    return torch.nn.functional.pad(x, flat)

kernel_name = 'recurrent_scan__softmax_full_mha__glu_gated_geglu__prompt'

def setup_inputs():

    _w = (lambda a: (lambda t: t.to(torch.bfloat16) if t.is_floating_point() else t)(torch.as_tensor(a)))
    def _A_setup():
        B, S, D = 1, 2048, 512
        return {
            "x": _w((lambda *s: torch.randn(*s, dtype=torch.bfloat16) * 0.05)(B, S, D)),
            "wqkv": _w((lambda *s: torch.randn(*s, dtype=torch.bfloat16) * 0.2)(D, 3 * D)),
            "wo": _w((lambda *s: torch.randn(*s, dtype=torch.bfloat16) * 0.2)(D, D)),
        }
    _A_in = _A_setup()

    def _B_setup():
        B, S, Dm, Df = 1, 2048, 512, 1792
        return {
            "x": _w((lambda *s: torch.randn(*s, dtype=torch.bfloat16) * 0.05)(B, S, Dm)),
            "w_gate": _w((lambda *s: torch.randn(*s, dtype=torch.bfloat16) * 0.1)(Dm, Df) * (Dm ** -0.5)),
            "w_up": _w((lambda *s: torch.randn(*s, dtype=torch.bfloat16) * 0.1)(Dm, Df) * (Dm ** -0.5)),
            "w_down": _w((lambda *s: torch.randn(*s, dtype=torch.bfloat16) * 0.1)(Df, Dm) * (Df ** -0.5)),
        }
    _B_in = _B_setup()

    return {
        "A_x": _A_in["x"],
        "A_wqkv": _A_in["wqkv"],
        "A_wo": _A_in["wo"],
        "B_x": _B_in["x"],
        "B_w_gate": _B_in["w_gate"],
        "B_w_up": _B_in["w_up"],
        "B_w_down": _B_in["w_down"],
    }

def reference(A_x, A_wqkv, A_wo, B_x, B_w_gate, B_w_up, B_w_down):
    def _A_ref(x, wqkv, wo):
        B, S, D = x.shape
        H = 32; Dh = D // H
        qkv = (lambda x, *d: x.permute(*d))((x @ wqkv).reshape(B, S, 3, H, Dh), 2, 0, 3, 1, 4)
        q, k, v = qkv[0], qkv[1], qkv[2]
        scale = Dh ** -0.5
        scores = torch.einsum("bhqd,bhkd->bhqk", q, k) * scale
        p = _softmax(scores, axis=-1)
        o = torch.einsum("bhqk,bhkd->bhqd", p, v)
        return (lambda x, *d: x.permute(*d))(o, 0, 2, 1, 3).reshape(B, S, D) @ wo

    def _B_ref(x, w_gate, w_up, w_down):
        g = torch.einsum("bsd,df->bsf", x, w_gate)
        u = torch.einsum("bsd,df->bsf", x, w_up)
        h = _gelu(g) * u
        return torch.einsum("bsf,fd->bsd", h, w_down)

    x = A_x
    xn = _layernorm(x, axis=-1)
    s = _A_ref(xn, A_wqkv, A_wo)
    g = _silu(_B_ref(xn, B_w_gate, B_w_up, B_w_down))
    return x + s * g
```

```asm
; @launch kernel=gemm1_kernel grid=(256,1,1) block=(768,1,1) lds=159232
; @launch kernel=attn_kernel grid=(256,1,1) block=(768,1,1) lds=147520
; @launch kernel=outp_kernel grid=(256,1,1) block=(256,1,1) lds=0
.amdgcn_target "amdgcn-amd-amdhsa--gfx950"
.text
.globl gemm1_kernel
.p2align 8
.type gemm1_kernel,@function
gemm1_kernel:
  s_cmp_ge_u32 s2, 256
  s_cbranch_scc1 gemm1_kernel_end

  s_load_dwordx2 s[4:5], s[0:1], 72
  s_load_dwordx2 s[50:51], s[0:1], 0
  s_load_dwordx2 s[70:71], s[0:1], 64
  s_load_dwordx2 s[6:7], s[0:1], 8
  s_load_dwordx2 s[8:9], s[0:1], 32
  s_load_dwordx2 s[10:11], s[0:1], 40
  v_lshrrev_b32 v5, 6, v0
  v_and_b32 v1, 63, v0
  s_and_b32 s3, s2, 7
  v_readfirstlane_b32 s14, v5
  s_lshr_b32 s15, s2, 3
  s_and_b32 s12, s3, 1
  s_lshl_b32 s12, s12, 3
  s_and_b32 s16, s15, 7
  s_add_u32 s12, s12, s16
  s_lshr_b32 s13, s3, 1
  s_lshl_b32 s13, s13, 2
  s_lshr_b32 s16, s15, 3
  s_add_u32 s13, s13, s16
  s_cmp_ge_u32 s14, 8
  s_cbranch_scc1 gemm1_kernel_loader

  v_and_b32 v5, 15, v1
  v_lshrrev_b32 v6, 1, v5
  v_lshrrev_b32 v7, 4, v1
  v_xor_b32 v6, v6, v7
  v_lshlrev_b32 v6, 4, v6
  v_lshl_add_u32 v5, v5, 7, v6
  s_and_b32 s16, s14, 1
  s_lshl_b32 s16, s16, 13
  v_add_u32 v2, s16, v5
  v_xor_b32 v3, 64, v2
  v_lshrrev_b32 v5, 4, v1
  v_and_b32 v6, 15, v1
  v_lshrrev_b32 v7, 2, v6
  v_lshl_add_u32 v12, v5, 2, v7
  v_and_b32 v5, 1, v5
  v_lshrrev_b32 v7, 1, v7
  v_lshl_add_u32 v5, v5, 1, v7
  s_lshr_b32 s16, s14, 1
  v_xor_b32 v5, s16, v5
  v_lshlrev_b32 v5, 5, v5
  v_and_b32 v6, 3, v6
  v_lshl_add_u32 v5, v6, 3, v5
  v_lshl_add_u32 v5, v12, 7, v5
  v_add_u32 v4, 32768, v5

  v_mov_b32 v8, 0x3f803f80
  v_mov_b32 v9, 0x3f803f80
  v_mov_b32 v10, 0x3f803f80
  v_mov_b32 v11, 0x3f803f80
  v_mov_b32 v88, 0
  v_mov_b32 v89, 0
  v_mov_b32 v90, 0
  v_mov_b32 v91, 0
  v_mov_b32 v92, 0
  v_mov_b32 v93, 0
  v_mov_b32 v94, 0
  v_mov_b32 v95, 0
  v_mov_b32 v96, 0
  v_mov_b32 v97, 0
  v_mov_b32 v98, 0
  v_mov_b32 v99, 0
  v_mov_b32 v100, 0
  v_mov_b32 v101, 0
  v_mov_b32 v102, 0
  v_mov_b32 v103, 0
  v_mov_b32 v104, 0
  v_mov_b32 v105, 0
  v_mov_b32 v106, 0
  v_mov_b32 v107, 0
  v_mov_b32 v108, 0
  v_mov_b32 v109, 0
  v_mov_b32 v110, 0
  v_mov_b32 v111, 0
  v_mov_b32 v112, 0
  v_mov_b32 v113, 0
  v_mov_b32 v114, 0
  v_mov_b32 v115, 0
  v_mov_b32 v116, 0
  v_mov_b32 v117, 0
  v_mov_b32 v118, 0
  v_mov_b32 v119, 0
  v_mov_b32 v120, 0
  v_mov_b32 v121, 0
  v_mov_b32 v122, 0
  v_mov_b32 v123, 0
  v_mov_b32 v124, 0
  v_mov_b32 v125, 0
  v_mov_b32 v126, 0
  v_mov_b32 v127, 0
  v_mov_b32 v128, 0
  v_mov_b32 v129, 0
  v_mov_b32 v130, 0
  v_mov_b32 v131, 0
  v_mov_b32 v132, 0
  v_mov_b32 v133, 0
  v_mov_b32 v134, 0
  v_mov_b32 v135, 0
  v_mov_b32 v136, 0
  v_mov_b32 v137, 0
  v_mov_b32 v138, 0
  v_mov_b32 v139, 0
  v_mov_b32 v140, 0
  v_mov_b32 v141, 0
  v_mov_b32 v142, 0
  v_mov_b32 v143, 0
  v_mov_b32 v144, 0
  v_mov_b32 v145, 0
  v_mov_b32 v146, 0
  v_mov_b32 v147, 0
  v_mov_b32 v148, 0
  v_mov_b32 v149, 0
  v_mov_b32 v150, 0
  v_mov_b32 v151, 0
  v_mov_b32 v152, 0
  v_mov_b32 v153, 0
  v_mov_b32 v154, 0
  v_mov_b32 v155, 0
  v_mov_b32 v156, 0
  v_mov_b32 v157, 0
  v_mov_b32 v158, 0
  v_mov_b32 v159, 0
  v_mov_b32 v160, 0
  v_mov_b32 v161, 0
  v_mov_b32 v162, 0
  v_mov_b32 v163, 0
  v_mov_b32 v164, 0
  v_mov_b32 v165, 0
  v_mov_b32 v166, 0
  v_mov_b32 v167, 0
  v_mov_b32 v68, 0
  v_mov_b32 v69, 0
  v_mov_b32 v70, 0
  v_mov_b32 v71, 0
  v_mov_b32 v72, 0
  v_mov_b32 v73, 0
  v_mov_b32 v74, 0
  v_mov_b32 v75, 0
  v_mov_b32 v76, 0
  v_mov_b32 v77, 0
  v_mov_b32 v78, 0
  v_mov_b32 v79, 0
  v_mov_b32 v80, 0
  v_mov_b32 v81, 0
  v_mov_b32 v82, 0
  v_mov_b32 v83, 0
  v_mov_b32 v84, 0
  v_mov_b32 v85, 0
  v_mov_b32 v86, 0
  v_mov_b32 v87, 0
  s_mov_b32 s40, 0
  s_mov_b32 s42, 0
  s_waitcnt lgkmcnt(0)
  s_and_b32 s16, s14, 1
  s_cmp_eq_u32 s16, 1
  s_cbranch_scc1 gemm1_kernel_wm1
  s_cmp_lt_u32 s13, 8
  s_cbranch_scc1 gemm1_kernel_vV0
  s_cmp_lt_u32 s13, 14
  s_cbranch_scc1 gemm1_kernel_vK0
  s_branch gemm1_kernel_vB0
  gemm1_kernel_wm1:
  s_cmp_lt_u32 s13, 8
  s_cbranch_scc1 gemm1_kernel_vV1
  s_cmp_lt_u32 s13, 14
  s_cbranch_scc1 gemm1_kernel_vK1
  s_branch gemm1_kernel_vB1

gemm1_kernel_vV0:
  s_barrier
  ds_read_b128 v[16:19], v2 offset:0
  ds_read_b128 v[20:23], v2 offset:2048
  ds_read_b128 v[24:27], v2 offset:4096
  ds_read_b128 v[28:31], v2 offset:6144
  ds_read_b64_tr_b16 v[48:49], v4 offset:0
  ds_read_b64_tr_b16 v[50:51], v4 offset:2048
  ds_read_b64_tr_b16 v[52:53], v4 offset:8192
  ds_read_b64_tr_b16 v[54:55], v4 offset:10240
  ds_read_b64_tr_b16 v[56:57], v4 offset:16384
  ds_read_b64_tr_b16 v[58:59], v4 offset:18432
  ds_read_b64_tr_b16 v[60:61], v4 offset:24576
  ds_read_b64_tr_b16 v[62:63], v4 offset:26624
  ds_read_b64_tr_b16 v[64:65], v4 offset:32768
  ds_read_b64_tr_b16 v[66:67], v4 offset:34816
gemm1_kernel_loopV0:
  s_waitcnt lgkmcnt(4)
  v_mfma_f32_16x16x32_bf16 v[88:91], v[48:51], v[16:19], v[88:91]
  v_mfma_f32_16x16x32_bf16 v[92:95], v[48:51], v[20:23], v[92:95]
  ds_read_b128 v[32:35], v3 offset:0
  v_mfma_f32_16x16x32_bf16 v[96:99], v[48:51], v[24:27], v[96:99]
  v_mfma_f32_16x16x32_bf16 v[100:103], v[48:51], v[28:31], v[100:103]
  v_mfma_f32_16x16x32_bf16 v[68:71], v[48:51], v[8:11], v[68:71]
  ds_read_b64_tr_b16 v[48:49], v4 offset:4096
  ds_read_b64_tr_b16 v[50:51], v4 offset:6144
  v_mfma_f32_16x16x32_bf16 v[104:107], v[52:55], v[16:19], v[104:107]
  v_mfma_f32_16x16x32_bf16 v[108:111], v[52:55], v[20:23], v[108:111]
  ds_read_b128 v[36:39], v3 offset:2048
  v_mfma_f32_16x16x32_bf16 v[112:115], v[52:55], v[24:27], v[112:115]
  v_mfma_f32_16x16x32_bf16 v[116:119], v[52:55], v[28:31], v[116:119]
  v_mfma_f32_16x16x32_bf16 v[72:75], v[52:55], v[8:11], v[72:75]
  ds_read_b64_tr_b16 v[52:53], v4 offset:12288
  ds_read_b64_tr_b16 v[54:55], v4 offset:14336
  v_mfma_f32_16x16x32_bf16 v[120:123], v[56:59], v[16:19], v[120:123]
  v_mfma_f32_16x16x32_bf16 v[124:127], v[56:59], v[20:23], v[124:127]
  ds_read_b128 v[40:43], v3 offset:4096
  v_mfma_f32_16x16x32_bf16 v[128:131], v[56:59], v[24:27], v[128:131]
  v_mfma_f32_16x16x32_bf16 v[132:135], v[56:59], v[28:31], v[132:135]
  v_mfma_f32_16x16x32_bf16 v[76:79], v[56:59], v[8:11], v[76:79]
  ds_read_b64_tr_b16 v[56:57], v4 offset:20480
  ds_read_b64_tr_b16 v[58:59], v4 offset:22528
  s_waitcnt lgkmcnt(11)
  v_mfma_f32_16x16x32_bf16 v[136:139], v[60:63], v[16:19], v[136:139]
  v_mfma_f32_16x16x32_bf16 v[140:143], v[60:63], v[20:23], v[140:143]
  ds_read_b128 v[44:47], v3 offset:6144
  v_mfma_f32_16x16x32_bf16 v[144:147], v[60:63], v[24:27], v[144:147]
  v_mfma_f32_16x16x32_bf16 v[148:151], v[60:63], v[28:31], v[148:151]
  v_mfma_f32_16x16x32_bf16 v[80:83], v[60:63], v[8:11], v[80:83]
  ds_read_b64_tr_b16 v[60:61], v4 offset:28672
  ds_read_b64_tr_b16 v[62:63], v4 offset:30720
  s_waitcnt lgkmcnt(12)
  v_mfma_f32_16x16x32_bf16 v[152:155], v[16:19], v[64:67], v[152:155]
  v_mfma_f32_16x16x32_bf16 v[156:159], v[20:23], v[64:67], v[156:159]
  v_mfma_f32_16x16x32_bf16 v[160:163], v[24:27], v[64:67], v[160:163]
  v_mfma_f32_16x16x32_bf16 v[164:167], v[28:31], v[64:67], v[164:167]
  v_mfma_f32_16x16x32_bf16 v[84:87], v[64:67], v[8:11], v[84:87]
  ds_read_b64_tr_b16 v[64:65], v4 offset:36864
  ds_read_b64_tr_b16 v[66:67], v4 offset:38912
  s_add_u32 s44, s42, 40960
  s_cmp_eq_u32 s44, 122880
  s_cselect_b32 s44, 0, s44
  s_sub_u32 s45, s44, s42
  s_mov_b32 s42, s44
  s_waitcnt lgkmcnt(0)
  v_xor_b32 v2, 16384, v2
  v_xor_b32 v3, 16384, v3
  v_add_u32 v4, s45, v4
  s_barrier

  s_waitcnt lgkmcnt(4)
  v_mfma_f32_16x16x32_bf16 v[88:91], v[48:51], v[32:35], v[88:91]
  v_mfma_f32_16x16x32_bf16 v[92:95], v[48:51], v[36:39], v[92:95]
  ds_read_b128 v[16:19], v2 offset:0
  v_mfma_f32_16x16x32_bf16 v[96:99], v[48:51], v[40:43], v[96:99]
  v_mfma_f32_16x16x32_bf16 v[100:103], v[48:51], v[44:47], v[100:103]
  ds_read_b64_tr_b16 v[48:49], v4 offset:0
  ds_read_b64_tr_b16 v[50:51], v4 offset:2048
  v_mfma_f32_16x16x32_bf16 v[104:107], v[52:55], v[32:35], v[104:107]
  v_mfma_f32_16x16x32_bf16 v[108:111], v[52:55], v[36:39], v[108:111]
  ds_read_b128 v[20:23], v2 offset:2048
  v_mfma_f32_16x16x32_bf16 v[112:115], v[52:55], v[40:43], v[112:115]
  v_mfma_f32_16x16x32_bf16 v[116:119], v[52:55], v[44:47], v[116:119]
  ds_read_b64_tr_b16 v[52:53], v4 offset:8192
  ds_read_b64_tr_b16 v[54:55], v4 offset:10240
  v_mfma_f32_16x16x32_bf16 v[120:123], v[56:59], v[32:35], v[120:123]
  v_mfma_f32_16x16x32_bf16 v[124:127], v[56:59], v[36:39], v[124:127]
  ds_read_b128 v[24:27], v2 offset:4096
  v_mfma_f32_16x16x32_bf16 v[128:131], v[56:59], v[40:43], v[128:131]
  v_mfma_f32_16x16x32_bf16 v[132:135], v[56:59], v[44:47], v[132:135]
  ds_read_b64_tr_b16 v[56:57], v4 offset:16384
  ds_read_b64_tr_b16 v[58:59], v4 offset:18432
  s_waitcnt lgkmcnt(11)
  v_mfma_f32_16x16x32_bf16 v[136:139], v[60:63], v[32:35], v[136:139]
  v_mfma_f32_16x16x32_bf16 v[140:143], v[60:63], v[36:39], v[140:143]
  ds_read_b128 v[28:31], v2 offset:6144
  v_mfma_f32_16x16x32_bf16 v[144:147], v[60:63], v[40:43], v[144:147]
  v_mfma_f32_16x16x32_bf16 v[148:151], v[60:63], v[44:47], v[148:151]
  ds_read_b64_tr_b16 v[60:61], v4 offset:24576
  ds_read_b64_tr_b16 v[62:63], v4 offset:26624
  s_waitcnt lgkmcnt(12)
  v_mfma_f32_16x16x32_bf16 v[152:155], v[32:35], v[64:67], v[152:155]
  v_mfma_f32_16x16x32_bf16 v[156:159], v[36:39], v[64:67], v[156:159]
  v_mfma_f32_16x16x32_bf16 v[160:163], v[40:43], v[64:67], v[160:163]
  v_mfma_f32_16x16x32_bf16 v[164:167], v[44:47], v[64:67], v[164:167]
  ds_read_b64_tr_b16 v[64:65], v4 offset:32768
  ds_read_b64_tr_b16 v[66:67], v4 offset:34816
  s_add_u32 s40, s40, 1
  s_cmp_lt_u32 s40, 8
  s_cbranch_scc1 gemm1_kernel_loopV0
  s_waitcnt lgkmcnt(0)
  s_branch gemm1_kernel_epiV

gemm1_kernel_vV1:
  s_barrier
  ds_read_b128 v[16:19], v2 offset:0
  ds_read_b128 v[20:23], v2 offset:2048
  ds_read_b128 v[24:27], v2 offset:4096
  ds_read_b128 v[28:31], v2 offset:6144
  ds_read_b64_tr_b16 v[48:49], v4 offset:0
  ds_read_b64_tr_b16 v[50:51], v4 offset:2048
  ds_read_b64_tr_b16 v[52:53], v4 offset:8192
  ds_read_b64_tr_b16 v[54:55], v4 offset:10240
  ds_read_b64_tr_b16 v[56:57], v4 offset:16384
  ds_read_b64_tr_b16 v[58:59], v4 offset:18432
  ds_read_b64_tr_b16 v[60:61], v4 offset:24576
  ds_read_b64_tr_b16 v[62:63], v4 offset:26624
  ds_read_b64_tr_b16 v[64:65], v4 offset:32768
  ds_read_b64_tr_b16 v[66:67], v4 offset:34816
gemm1_kernel_loopV1:
  s_waitcnt lgkmcnt(4)
  v_mfma_f32_16x16x32_bf16 v[88:91], v[48:51], v[16:19], v[88:91]
  v_mfma_f32_16x16x32_bf16 v[92:95], v[48:51], v[20:23], v[92:95]
  ds_read_b128 v[32:35], v3 offset:0
  v_mfma_f32_16x16x32_bf16 v[96:99], v[48:51], v[24:27], v[96:99]
  v_mfma_f32_16x16x32_bf16 v[100:103], v[48:51], v[28:31], v[100:103]
  ds_read_b64_tr_b16 v[48:49], v4 offset:4096
  ds_read_b64_tr_b16 v[50:51], v4 offset:6144
  v_mfma_f32_16x16x32_bf16 v[104:107], v[52:55], v[16:19], v[104:107]
  v_mfma_f32_16x16x32_bf16 v[108:111], v[52:55], v[20:23], v[108:111]
  ds_read_b128 v[36:39], v3 offset:2048
  v_mfma_f32_16x16x32_bf16 v[112:115], v[52:55], v[24:27], v[112:115]
  v_mfma_f32_16x16x32_bf16 v[116:119], v[52:55], v[28:31], v[116:119]
  ds_read_b64_tr_b16 v[52:53], v4 offset:12288
  ds_read_b64_tr_b16 v[54:55], v4 offset:14336
  v_mfma_f32_16x16x32_bf16 v[120:123], v[56:59], v[16:19], v[120:123]
  v_mfma_f32_16x16x32_bf16 v[124:127], v[56:59], v[20:23], v[124:127]
  ds_read_b128 v[40:43], v3 offset:4096
  v_mfma_f32_16x16x32_bf16 v[128:131], v[56:59], v[24:27], v[128:131]
  v_mfma_f32_16x16x32_bf16 v[132:135], v[56:59], v[28:31], v[132:135]
  ds_read_b64_tr_b16 v[56:57], v4 offset:20480
  ds_read_b64_tr_b16 v[58:59], v4 offset:22528
  s_waitcnt lgkmcnt(11)
  v_mfma_f32_16x16x32_bf16 v[136:139], v[60:63], v[16:19], v[136:139]
  v_mfma_f32_16x16x32_bf16 v[140:143], v[60:63], v[20:23], v[140:143]
  ds_read_b128 v[44:47], v3 offset:6144
  v_mfma_f32_16x16x32_bf16 v[144:147], v[60:63], v[24:27], v[144:147]
  v_mfma_f32_16x16x32_bf16 v[148:151], v[60:63], v[28:31], v[148:151]
  ds_read_b64_tr_b16 v[60:61], v4 offset:28672
  ds_read_b64_tr_b16 v[62:63], v4 offset:30720
  s_waitcnt lgkmcnt(12)
  v_mfma_f32_16x16x32_bf16 v[152:155], v[16:19], v[64:67], v[152:155]
  v_mfma_f32_16x16x32_bf16 v[156:159], v[20:23], v[64:67], v[156:159]
  v_mfma_f32_16x16x32_bf16 v[160:163], v[24:27], v[64:67], v[160:163]
  v_mfma_f32_16x16x32_bf16 v[164:167], v[28:31], v[64:67], v[164:167]
  ds_read_b64_tr_b16 v[64:65], v4 offset:36864
  ds_read_b64_tr_b16 v[66:67], v4 offset:38912
  s_add_u32 s44, s42, 40960
  s_cmp_eq_u32 s44, 122880
  s_cselect_b32 s44, 0, s44
  s_sub_u32 s45, s44, s42
  s_mov_b32 s42, s44
  s_waitcnt lgkmcnt(0)
  v_xor_b32 v2, 16384, v2
  v_xor_b32 v3, 16384, v3
  v_add_u32 v4, s45, v4
  s_barrier

  s_waitcnt lgkmcnt(4)
  v_mfma_f32_16x16x32_bf16 v[88:91], v[48:51], v[32:35], v[88:91]
  v_mfma_f32_16x16x32_bf16 v[92:95], v[48:51], v[36:39], v[92:95]
  ds_read_b128 v[16:19], v2 offset:0
  v_mfma_f32_16x16x32_bf16 v[96:99], v[48:51], v[40:43], v[96:99]
  v_mfma_f32_16x16x32_bf16 v[100:103], v[48:51], v[44:47], v[100:103]
  v_mfma_f32_16x16x32_bf16 v[68:71], v[48:51], v[8:11], v[68:71]
  ds_read_b64_tr_b16 v[48:49], v4 offset:0
  ds_read_b64_tr_b16 v[50:51], v4 offset:2048
  v_mfma_f32_16x16x32_bf16 v[104:107], v[52:55], v[32:35], v[104:107]
  v_mfma_f32_16x16x32_bf16 v[108:111], v[52:55], v[36:39], v[108:111]
  ds_read_b128 v[20:23], v2 offset:2048
  v_mfma_f32_16x16x32_bf16 v[112:115], v[52:55], v[40:43], v[112:115]
  v_mfma_f32_16x16x32_bf16 v[116:119], v[52:55], v[44:47], v[116:119]
  v_mfma_f32_16x16x32_bf16 v[72:75], v[52:55], v[8:11], v[72:75]
  ds_read_b64_tr_b16 v[52:53], v4 offset:8192
  ds_read_b64_tr_b16 v[54:55], v4 offset:10240
  v_mfma_f32_16x16x32_bf16 v[120:123], v[56:59], v[32:35], v[120:123]
  v_mfma_f32_16x16x32_bf16 v[124:127], v[56:59], v[36:39], v[124:127]
  ds_read_b128 v[24:27], v2 offset:4096
  v_mfma_f32_16x16x32_bf16 v[128:131], v[56:59], v[40:43], v[128:131]
  v_mfma_f32_16x16x32_bf16 v[132:135], v[56:59], v[44:47], v[132:135]
  v_mfma_f32_16x16x32_bf16 v[76:79], v[56:59], v[8:11], v[76:79]
  ds_read_b64_tr_b16 v[56:57], v4 offset:16384
  ds_read_b64_tr_b16 v[58:59], v4 offset:18432
  s_waitcnt lgkmcnt(11)
  v_mfma_f32_16x16x32_bf16 v[136:139], v[60:63], v[32:35], v[136:139]
  v_mfma_f32_16x16x32_bf16 v[140:143], v[60:63], v[36:39], v[140:143]
  ds_read_b128 v[28:31], v2 offset:6144
  v_mfma_f32_16x16x32_bf16 v[144:147], v[60:63], v[40:43], v[144:147]
  v_mfma_f32_16x16x32_bf16 v[148:151], v[60:63], v[44:47], v[148:151]
  v_mfma_f32_16x16x32_bf16 v[80:83], v[60:63], v[8:11], v[80:83]
  ds_read_b64_tr_b16 v[60:61], v4 offset:24576
  ds_read_b64_tr_b16 v[62:63], v4 offset:26624
  s_waitcnt lgkmcnt(12)
  v_mfma_f32_16x16x32_bf16 v[152:155], v[32:35], v[64:67], v[152:155]
  v_mfma_f32_16x16x32_bf16 v[156:159], v[36:39], v[64:67], v[156:159]
  v_mfma_f32_16x16x32_bf16 v[160:163], v[40:43], v[64:67], v[160:163]
  v_mfma_f32_16x16x32_bf16 v[164:167], v[44:47], v[64:67], v[164:167]
  v_mfma_f32_16x16x32_bf16 v[84:87], v[64:67], v[8:11], v[84:87]
  ds_read_b64_tr_b16 v[64:65], v4 offset:32768
  ds_read_b64_tr_b16 v[66:67], v4 offset:34816
  s_add_u32 s40, s40, 1
  s_cmp_lt_u32 s40, 8
  s_cbranch_scc1 gemm1_kernel_loopV1
  s_waitcnt lgkmcnt(0)
  s_branch gemm1_kernel_epiV

gemm1_kernel_epiV:
  s_nop 7
  s_nop 3
  s_and_b32 s16, s14, 1
  s_mul_i32 s16, s16, 1280
  s_lshr_b32 s15, s14, 1
  s_lshl_b32 s17, s15, 6
  s_add_u32 s16, s16, s17
  s_add_u32 s16, s16, 156672
  v_lshrrev_b32 v6, 4, v1
  v_lshl_add_u32 v16, v6, 4, s16

  ds_write_b128 v16, v[68:71] offset:0
  ds_write_b128 v16, v[72:75] offset:256
  ds_write_b128 v16, v[76:79] offset:512
  ds_write_b128 v16, v[80:83] offset:768
  ds_write_b128 v16, v[84:87] offset:1024
  s_waitcnt lgkmcnt(0)
  s_barrier
  s_and_b32 s30, s14, 1
  s_lshl_b32 s30, s30, 6
  s_lshl_b32 s31, s12, 7
  s_add_u32 s30, s30, s31
  v_and_b32 v5, 15, v1
  s_mov_b32 s40, 0xc0135761
  s_mov_b32 s41, 0xbdd2d3e8
  s_mov_b32 s42, 0x3eb8aa3b

  s_and_b32 s16, s14, 1
  s_lshl_b32 s16, s16, 8
  s_add_u32 s16, s16, 155648
  v_lshl_add_u32 v16, v5, 2, s16
  s_lshl_b32 s17, s15, 6
  s_add_u32 s17, s17, 156672
  v_lshl_add_u32 v17, v6, 4, s17

  ds_read_b32 v56, v16 offset:0
  ds_read_b32 v60, v16 offset:512
  ds_read_b32 v57, v16 offset:64
  ds_read_b32 v61, v16 offset:576
  ds_read_b32 v58, v16 offset:128
  ds_read_b32 v62, v16 offset:640
  ds_read_b32 v59, v16 offset:192
  ds_read_b32 v63, v16 offset:704
  ds_read_b128 v[64:67], v17 offset:0
  ds_read_b128 v[20:23], v17 offset:1280
  ds_read_b128 v[68:71], v17 offset:256
  ds_read_b128 v[24:27], v17 offset:1536
  ds_read_b128 v[72:75], v17 offset:512
  ds_read_b128 v[28:31], v17 offset:1792
  ds_read_b128 v[76:79], v17 offset:768
  ds_read_b128 v[32:35], v17 offset:2048
  v_lshl_add_u32 v18, v6, 4, s16
  v_lshl_add_u32 v19, v5, 2, s17
  ds_read_b32 v40, v19 offset:1024
  ds_read_b32 v41, v19 offset:2304

  s_waitcnt lgkmcnt(0)
  v_add_f32 v64, v64, v20
  v_add_f32 v65, v65, v21
  v_add_f32 v66, v66, v22
  v_add_f32 v67, v67, v23
  v_add_f32 v68, v68, v24
  v_add_f32 v69, v69, v25
  v_add_f32 v70, v70, v26
  v_add_f32 v71, v71, v27
  v_add_f32 v72, v72, v28
  v_add_f32 v73, v73, v29
  v_add_f32 v74, v74, v30
  v_add_f32 v75, v75, v31
  v_add_f32 v76, v76, v32
  v_add_f32 v77, v77, v33
  v_add_f32 v78, v78, v34
  v_add_f32 v79, v79, v35
  v_fma_f32 v88, v60, v64, v88
  v_fma_f32 v89, v60, v65, v89
  v_fma_f32 v90, v60, v66, v90
  v_fma_f32 v91, v60, v67, v91
  v_mul_f32 v88, v56, v88
  v_mul_f32 v89, v56, v89
  v_mul_f32 v90, v56, v90
  v_mul_f32 v91, v56, v91
  v_fma_f32 v92, v61, v64, v92
  v_fma_f32 v93, v61, v65, v93
  v_fma_f32 v94, v61, v66, v94
  v_fma_f32 v95, v61, v67, v95
  v_mul_f32 v92, v57, v92
  v_mul_f32 v93, v57, v93
  v_mul_f32 v94, v57, v94
  v_mul_f32 v95, v57, v95
  v_fma_f32 v96, v62, v64, v96
  v_fma_f32 v97, v62, v65, v97
  v_fma_f32 v98, v62, v66, v98
  v_fma_f32 v99, v62, v67, v99
  v_mul_f32 v96, v58, v96
  v_mul_f32 v97, v58, v97
  v_mul_f32 v98, v58, v98
  v_mul_f32 v99, v58, v99
  v_fma_f32 v100, v63, v64, v100
  v_fma_f32 v101, v63, v65, v101
  v_fma_f32 v102, v63, v66, v102
  v_fma_f32 v103, v63, v67, v103
  v_mul_f32 v100, v59, v100
  v_mul_f32 v101, v59, v101
  v_mul_f32 v102, v59, v102
  v_mul_f32 v103, v59, v103
  v_fma_f32 v104, v60, v68, v104
  v_fma_f32 v105, v60, v69, v105
  v_fma_f32 v106, v60, v70, v106
  v_fma_f32 v107, v60, v71, v107
  v_mul_f32 v104, v56, v104
  v_mul_f32 v105, v56, v105
  v_mul_f32 v106, v56, v106
  v_mul_f32 v107, v56, v107
  v_fma_f32 v108, v61, v68, v108
  v_fma_f32 v109, v61, v69, v109
  v_fma_f32 v110, v61, v70, v110
  v_fma_f32 v111, v61, v71, v111
  v_mul_f32 v108, v57, v108
  v_mul_f32 v109, v57, v109
  v_mul_f32 v110, v57, v110
  v_mul_f32 v111, v57, v111
  v_fma_f32 v112, v62, v68, v112
  v_fma_f32 v113, v62, v69, v113
  v_fma_f32 v114, v62, v70, v114
  v_fma_f32 v115, v62, v71, v115
  v_mul_f32 v112, v58, v112
  v_mul_f32 v113, v58, v113
  v_mul_f32 v114, v58, v114
  v_mul_f32 v115, v58, v115
  v_fma_f32 v116, v63, v68, v116
  v_fma_f32 v117, v63, v69, v117
  v_fma_f32 v118, v63, v70, v118
  v_fma_f32 v119, v63, v71, v119
  v_mul_f32 v116, v59, v116
  v_mul_f32 v117, v59, v117
  v_mul_f32 v118, v59, v118
  v_mul_f32 v119, v59, v119
  v_fma_f32 v120, v60, v72, v120
  v_fma_f32 v121, v60, v73, v121
  v_fma_f32 v122, v60, v74, v122
  v_fma_f32 v123, v60, v75, v123
  v_mul_f32 v120, v56, v120
  v_mul_f32 v121, v56, v121
  v_mul_f32 v122, v56, v122
  v_mul_f32 v123, v56, v123
  v_fma_f32 v124, v61, v72, v124
  v_fma_f32 v125, v61, v73, v125
  v_fma_f32 v126, v61, v74, v126
  v_fma_f32 v127, v61, v75, v127
  v_mul_f32 v124, v57, v124
  v_mul_f32 v125, v57, v125
  v_mul_f32 v126, v57, v126
  v_mul_f32 v127, v57, v127
  v_fma_f32 v128, v62, v72, v128
  v_fma_f32 v129, v62, v73, v129
  v_fma_f32 v130, v62, v74, v130
  v_fma_f32 v131, v62, v75, v131
  v_mul_f32 v128, v58, v128
  v_mul_f32 v129, v58, v129
  v_mul_f32 v130, v58, v130
  v_mul_f32 v131, v58, v131
  v_fma_f32 v132, v63, v72, v132
  v_fma_f32 v133, v63, v73, v133
  v_fma_f32 v134, v63, v74, v134
  v_fma_f32 v135, v63, v75, v135
  v_mul_f32 v132, v59, v132
  v_mul_f32 v133, v59, v133
  v_mul_f32 v134, v59, v134
  v_mul_f32 v135, v59, v135
  v_fma_f32 v136, v60, v76, v136
  v_fma_f32 v137, v60, v77, v137
  v_fma_f32 v138, v60, v78, v138
  v_fma_f32 v139, v60, v79, v139
  v_mul_f32 v136, v56, v136
  v_mul_f32 v137, v56, v137
  v_mul_f32 v138, v56, v138
  v_mul_f32 v139, v56, v139
  v_fma_f32 v140, v61, v76, v140
  v_fma_f32 v141, v61, v77, v141
  v_fma_f32 v142, v61, v78, v142
  v_fma_f32 v143, v61, v79, v143
  v_mul_f32 v140, v57, v140
  v_mul_f32 v141, v57, v141
  v_mul_f32 v142, v57, v142
  v_mul_f32 v143, v57, v143
  v_fma_f32 v144, v62, v76, v144
  v_fma_f32 v145, v62, v77, v145
  v_fma_f32 v146, v62, v78, v146
  v_fma_f32 v147, v62, v79, v147
  v_mul_f32 v144, v58, v144
  v_mul_f32 v145, v58, v145
  v_mul_f32 v146, v58, v146
  v_mul_f32 v147, v58, v147
  v_fma_f32 v148, v63, v76, v148
  v_fma_f32 v149, v63, v77, v149
  v_fma_f32 v150, v63, v78, v150
  v_fma_f32 v151, v63, v79, v151
  v_mul_f32 v148, v59, v148
  v_mul_f32 v149, v59, v149
  v_mul_f32 v150, v59, v150
  v_mul_f32 v151, v59, v151
  v_add_f32 v40, v40, v41
  ds_read_b128 v[44:47], v18 offset:0
  ds_read_b128 v[48:51], v18 offset:512
  s_waitcnt lgkmcnt(0)
  v_fma_f32 v152, v48, v40, v152
  v_fma_f32 v153, v49, v40, v153
  v_fma_f32 v154, v50, v40, v154
  v_fma_f32 v155, v51, v40, v155
  v_mul_f32 v152, v44, v152
  v_mul_f32 v153, v45, v153
  v_mul_f32 v154, v46, v154
  v_mul_f32 v155, v47, v155
  ds_read_b128 v[44:47], v18 offset:64
  ds_read_b128 v[48:51], v18 offset:576
  s_waitcnt lgkmcnt(0)
  v_fma_f32 v156, v48, v40, v156
  v_fma_f32 v157, v49, v40, v157
  v_fma_f32 v158, v50, v40, v158
  v_fma_f32 v159, v51, v40, v159
  v_mul_f32 v156, v44, v156
  v_mul_f32 v157, v45, v157
  v_mul_f32 v158, v46, v158
  v_mul_f32 v159, v47, v159
  ds_read_b128 v[44:47], v18 offset:128
  ds_read_b128 v[48:51], v18 offset:640
  s_waitcnt lgkmcnt(0)
  v_fma_f32 v160, v48, v40, v160
  v_fma_f32 v161, v49, v40, v161
  v_fma_f32 v162, v50, v40, v162
  v_fma_f32 v163, v51, v40, v163
  v_mul_f32 v160, v44, v160
  v_mul_f32 v161, v45, v161
  v_mul_f32 v162, v46, v162
  v_mul_f32 v163, v47, v163
  ds_read_b128 v[44:47], v18 offset:192
  ds_read_b128 v[48:51], v18 offset:704
  s_waitcnt lgkmcnt(0)
  v_fma_f32 v164, v48, v40, v164
  v_fma_f32 v165, v49, v40, v165
  v_fma_f32 v166, v50, v40, v166
  v_fma_f32 v167, v51, v40, v167
  v_mul_f32 v164, v44, v164
  v_mul_f32 v165, v45, v165
  v_mul_f32 v166, v46, v166
  v_mul_f32 v167, v47, v167
  v_lshlrev_b32 v13, 4, v5
  v_lshrrev_b32 v7, 1, v6
  v_lshl_add_u32 v13, v7, 9, v13
  v_and_b32 v12, 1, v6
  v_lshl_add_u32 v13, v12, 3, v13
  v_lshlrev_b32 v14, 4, v5
  v_lshl_add_u32 v14, v12, 8, v14
  v_lshl_add_u32 v14, v7, 3, v14
  s_lshl_b32 s34, s30, 5

  s_lshl_b32 s35, s13, 2
  s_add_u32 s35, s35, s15
  s_lshl_b32 s35, s35, 16
  s_add_u32 s35, s35, s34
  s_add_u32 s35, s35, 6291456
  s_add_u32 s36, s4, s35
  s_addc_u32 s37, s5, 0

  v_cvt_pk_bf16_f32 v40, v152, v153
  v_cvt_pk_bf16_f32 v41, v154, v155
  global_store_dwordx2 v14, v[40:41], s[36:37] offset:0
  v_cvt_pk_bf16_f32 v42, v156, v157
  v_cvt_pk_bf16_f32 v43, v158, v159
  global_store_dwordx2 v14, v[42:43], s[36:37] offset:512
  v_cvt_pk_bf16_f32 v44, v160, v161
  v_cvt_pk_bf16_f32 v45, v162, v163
  global_store_dwordx2 v14, v[44:45], s[36:37] offset:1024
  v_cvt_pk_bf16_f32 v46, v164, v165
  v_cvt_pk_bf16_f32 v47, v166, v167
  global_store_dwordx2 v14, v[46:47], s[36:37] offset:1536
  s_lshr_b32 s32, s30, 5
  s_mul_i32 s32, s32, 112
  s_lshl_b32 s33, s13, 3
  s_add_u32 s32, s32, s33
  s_add_u32 s32, s32, s15
  s_lshl_b32 s32, s32, 10
  s_add_u32 s32, s32, 8388608
  s_add_u32 s32, s4, s32
  s_addc_u32 s33, s5, 0
  s_add_u32 s88, s32, 4096
  s_addc_u32 s89, s33, 0
  v_mov_b32 v8, s40

  v_lshlrev_b32 v15, 4, v1
  v_mul_f32 v16, v88, v88
  v_mul_f32 v17, v89, v89
  v_mul_f32 v18, v90, v90
  v_mul_f32 v19, v91, v91
  v_fma_f32 v16, v16, s41, v8
  v_fma_f32 v17, v17, s41, v8
  v_fma_f32 v18, v18, s41, v8
  v_fma_f32 v19, v19, s41, v8
  v_mul_f32 v16, v16, v88
  v_mul_f32 v17, v17, v89
  v_mul_f32 v18, v18, v90
  v_mul_f32 v19, v19, v91
  v_exp_f32 v16, v16
  v_exp_f32 v17, v17
  v_exp_f32 v18, v18
  v_exp_f32 v19, v19
  v_mul_f32 v20, v88, v120
  v_mul_f32 v21, v89, v121
  v_mul_f32 v22, v90, v122
  v_mul_f32 v23, v91, v123
  v_add_f32 v16, 1.0, v16
  v_add_f32 v17, 1.0, v17
  v_add_f32 v18, 1.0, v18
  v_add_f32 v19, 1.0, v19
  v_rcp_f32 v16, v16
  v_rcp_f32 v17, v17
  v_rcp_f32 v18, v18
  v_rcp_f32 v19, v19
  s_nop 0
  v_mul_f32 v16, v16, v20
  v_mul_f32 v17, v17, v21
  v_mul_f32 v18, v18, v22
  v_mul_f32 v19, v19, v23
  v_cvt_pk_bf16_f32 v32, v16, v17
  v_cvt_pk_bf16_f32 v33, v18, v19
  v_mul_f32 v16, v92, v92
  v_mul_f32 v17, v93, v93
  v_mul_f32 v18, v94, v94
  v_mul_f32 v19, v95, v95
  v_fma_f32 v16, v16, s41, v8
  v_fma_f32 v17, v17, s41, v8
  v_fma_f32 v18, v18, s41, v8
  v_fma_f32 v19, v19, s41, v8
  v_mul_f32 v16, v16, v92
  v_mul_f32 v17, v17, v93
  v_mul_f32 v18, v18, v94
  v_mul_f32 v19, v19, v95
  v_exp_f32 v16, v16
  v_exp_f32 v17, v17
  v_exp_f32 v18, v18
  v_exp_f32 v19, v19
  v_mul_f32 v20, v92, v124
  v_mul_f32 v21, v93, v125
  v_mul_f32 v22, v94, v126
  v_mul_f32 v23, v95, v127
  v_add_f32 v16, 1.0, v16
  v_add_f32 v17, 1.0, v17
  v_add_f32 v18, 1.0, v18
  v_add_f32 v19, 1.0, v19
  v_rcp_f32 v16, v16
  v_rcp_f32 v17, v17
  v_rcp_f32 v18, v18
  v_rcp_f32 v19, v19
  s_nop 0
  v_mul_f32 v16, v16, v20
  v_mul_f32 v17, v17, v21
  v_mul_f32 v18, v18, v22
  v_mul_f32 v19, v19, v23
  v_cvt_pk_bf16_f32 v34, v16, v17
  v_cvt_pk_bf16_f32 v35, v18, v19
  s_nop 1
  v_permlane16_swap_b32 v32, v34
  v_permlane16_swap_b32 v33, v35
  s_nop 1
  global_store_dwordx4 v15, v[32:35], s[32:33]
  v_mul_f32 v16, v104, v104
  v_mul_f32 v17, v105, v105
  v_mul_f32 v18, v106, v106
  v_mul_f32 v19, v107, v107
  v_fma_f32 v16, v16, s41, v8
  v_fma_f32 v17, v17, s41, v8
  v_fma_f32 v18, v18, s41, v8
  v_fma_f32 v19, v19, s41, v8
  v_mul_f32 v16, v16, v104
  v_mul_f32 v17, v17, v105
  v_mul_f32 v18, v18, v106
  v_mul_f32 v19, v19, v107
  v_exp_f32 v16, v16
  v_exp_f32 v17, v17
  v_exp_f32 v18, v18
  v_exp_f32 v19, v19
  v_mul_f32 v20, v104, v136
  v_mul_f32 v21, v105, v137
  v_mul_f32 v22, v106, v138
  v_mul_f32 v23, v107, v139
  v_add_f32 v16, 1.0, v16
  v_add_f32 v17, 1.0, v17
  v_add_f32 v18, 1.0, v18
  v_add_f32 v19, 1.0, v19
  v_rcp_f32 v16, v16
  v_rcp_f32 v17, v17
  v_rcp_f32 v18, v18
  v_rcp_f32 v19, v19
  s_nop 0
  v_mul_f32 v16, v16, v20
  v_mul_f32 v17, v17, v21
  v_mul_f32 v18, v18, v22
  v_mul_f32 v19, v19, v23
  v_cvt_pk_bf16_f32 v36, v16, v17
  v_cvt_pk_bf16_f32 v37, v18, v19
  v_mul_f32 v16, v108, v108
  v_mul_f32 v17, v109, v109
  v_mul_f32 v18, v110, v110
  v_mul_f32 v19, v111, v111
  v_fma_f32 v16, v16, s41, v8
  v_fma_f32 v17, v17, s41, v8
  v_fma_f32 v18, v18, s41, v8
  v_fma_f32 v19, v19, s41, v8
  v_mul_f32 v16, v16, v108
  v_mul_f32 v17, v17, v109
  v_mul_f32 v18, v18, v110
  v_mul_f32 v19, v19, v111
  v_exp_f32 v16, v16
  v_exp_f32 v17, v17
  v_exp_f32 v18, v18
  v_exp_f32 v19, v19
  v_mul_f32 v20, v108, v140
  v_mul_f32 v21, v109, v141
  v_mul_f32 v22, v110, v142
  v_mul_f32 v23, v111, v143
  v_add_f32 v16, 1.0, v16
  v_add_f32 v17, 1.0, v17
  v_add_f32 v18, 1.0, v18
  v_add_f32 v19, 1.0, v19
  v_rcp_f32 v16, v16
  v_rcp_f32 v17, v17
  v_rcp_f32 v18, v18
  v_rcp_f32 v19, v19
  s_nop 0
  v_mul_f32 v16, v16, v20
  v_mul_f32 v17, v17, v21
  v_mul_f32 v18, v18, v22
  v_mul_f32 v19, v19, v23
  v_cvt_pk_bf16_f32 v38, v16, v17
  v_cvt_pk_bf16_f32 v39, v18, v19
  s_nop 1
  v_permlane16_swap_b32 v36, v38
  v_permlane16_swap_b32 v37, v39
  s_nop 1
  global_store_dwordx4 v15, v[36:39], s[88:89]
  s_add_u32 s32, s32, 114688
  s_addc_u32 s33, s33, 0
  s_add_u32 s88, s88, 114688
  s_addc_u32 s89, s89, 0
  v_mul_f32 v16, v96, v96
  v_mul_f32 v17, v97, v97
  v_mul_f32 v18, v98, v98
  v_mul_f32 v19, v99, v99
  v_fma_f32 v16, v16, s41, v8
  v_fma_f32 v17, v17, s41, v8
  v_fma_f32 v18, v18, s41, v8
  v_fma_f32 v19, v19, s41, v8
  v_mul_f32 v16, v16, v96
  v_mul_f32 v17, v17, v97
  v_mul_f32 v18, v18, v98
  v_mul_f32 v19, v19, v99
  v_exp_f32 v16, v16
  v_exp_f32 v17, v17
  v_exp_f32 v18, v18
  v_exp_f32 v19, v19
  v_mul_f32 v20, v96, v128
  v_mul_f32 v21, v97, v129
  v_mul_f32 v22, v98, v130
  v_mul_f32 v23, v99, v131
  v_add_f32 v16, 1.0, v16
  v_add_f32 v17, 1.0, v17
  v_add_f32 v18, 1.0, v18
  v_add_f32 v19, 1.0, v19
  v_rcp_f32 v16, v16
  v_rcp_f32 v17, v17
  v_rcp_f32 v18, v18
  v_rcp_f32 v19, v19
  s_nop 0
  v_mul_f32 v16, v16, v20
  v_mul_f32 v17, v17, v21
  v_mul_f32 v18, v18, v22
  v_mul_f32 v19, v19, v23
  v_cvt_pk_bf16_f32 v32, v16, v17
  v_cvt_pk_bf16_f32 v33, v18, v19
  v_mul_f32 v16, v100, v100
  v_mul_f32 v17, v101, v101
  v_mul_f32 v18, v102, v102
  v_mul_f32 v19, v103, v103
  v_fma_f32 v16, v16, s41, v8
  v_fma_f32 v17, v17, s41, v8
  v_fma_f32 v18, v18, s41, v8
  v_fma_f32 v19, v19, s41, v8
  v_mul_f32 v16, v16, v100
  v_mul_f32 v17, v17, v101
  v_mul_f32 v18, v18, v102
  v_mul_f32 v19, v19, v103
  v_exp_f32 v16, v16
  v_exp_f32 v17, v17
  v_exp_f32 v18, v18
  v_exp_f32 v19, v19
  v_mul_f32 v20, v100, v132
  v_mul_f32 v21, v101, v133
  v_mul_f32 v22, v102, v134
  v_mul_f32 v23, v103, v135
  v_add_f32 v16, 1.0, v16
  v_add_f32 v17, 1.0, v17
  v_add_f32 v18, 1.0, v18
  v_add_f32 v19, 1.0, v19
  v_rcp_f32 v16, v16
  v_rcp_f32 v17, v17
  v_rcp_f32 v18, v18
  v_rcp_f32 v19, v19
  s_nop 0
  v_mul_f32 v16, v16, v20
  v_mul_f32 v17, v17, v21
  v_mul_f32 v18, v18, v22
  v_mul_f32 v19, v19, v23
  v_cvt_pk_bf16_f32 v34, v16, v17
  v_cvt_pk_bf16_f32 v35, v18, v19
  s_nop 1
  v_permlane16_swap_b32 v32, v34
  v_permlane16_swap_b32 v33, v35
  s_nop 1
  global_store_dwordx4 v15, v[32:35], s[32:33]
  v_mul_f32 v16, v112, v112
  v_mul_f32 v17, v113, v113
  v_mul_f32 v18, v114, v114
  v_mul_f32 v19, v115, v115
  v_fma_f32 v16, v16, s41, v8
  v_fma_f32 v17, v17, s41, v8
  v_fma_f32 v18, v18, s41, v8
  v_fma_f32 v19, v19, s41, v8
  v_mul_f32 v16, v16, v112
  v_mul_f32 v17, v17, v113
  v_mul_f32 v18, v18, v114
  v_mul_f32 v19, v19, v115
  v_exp_f32 v16, v16
  v_exp_f32 v17, v17
  v_exp_f32 v18, v18
  v_exp_f32 v19, v19
  v_mul_f32 v20, v112, v144
  v_mul_f32 v21, v113, v145
  v_mul_f32 v22, v114, v146
  v_mul_f32 v23, v115, v147
  v_add_f32 v16, 1.0, v16
  v_add_f32 v17, 1.0, v17
  v_add_f32 v18, 1.0, v18
  v_add_f32 v19, 1.0, v19
  v_rcp_f32 v16, v16
  v_rcp_f32 v17, v17
  v_rcp_f32 v18, v18
  v_rcp_f32 v19, v19
  s_nop 0
  v_mul_f32 v16, v16, v20
  v_mul_f32 v17, v17, v21
  v_mul_f32 v18, v18, v22
  v_mul_f32 v19, v19, v23
  v_cvt_pk_bf16_f32 v36, v16, v17
  v_cvt_pk_bf16_f32 v37, v18, v19
  v_mul_f32 v16, v116, v116
  v_mul_f32 v17, v117, v117
  v_mul_f32 v18, v118, v118
  v_mul_f32 v19, v119, v119
  v_fma_f32 v16, v16, s41, v8
  v_fma_f32 v17, v17, s41, v8
  v_fma_f32 v18, v18, s41, v8
  v_fma_f32 v19, v19, s41, v8
  v_mul_f32 v16, v16, v116
  v_mul_f32 v17, v17, v117
  v_mul_f32 v18, v18, v118
  v_mul_f32 v19, v19, v119
  v_exp_f32 v16, v16
  v_exp_f32 v17, v17
  v_exp_f32 v18, v18
  v_exp_f32 v19, v19
  v_mul_f32 v20, v116, v148
  v_mul_f32 v21, v117, v149
  v_mul_f32 v22, v118, v150
  v_mul_f32 v23, v119, v151
  v_add_f32 v16, 1.0, v16
  v_add_f32 v17, 1.0, v17
  v_add_f32 v18, 1.0, v18
  v_add_f32 v19, 1.0, v19
  v_rcp_f32 v16, v16
  v_rcp_f32 v17, v17
  v_rcp_f32 v18, v18
  v_rcp_f32 v19, v19
  s_nop 0
  v_mul_f32 v16, v16, v20
  v_mul_f32 v17, v17, v21
  v_mul_f32 v18, v18, v22
  v_mul_f32 v19, v19, v23
  v_cvt_pk_bf16_f32 v38, v16, v17
  v_cvt_pk_bf16_f32 v39, v18, v19
  s_nop 1
  v_permlane16_swap_b32 v36, v38
  v_permlane16_swap_b32 v37, v39
  s_nop 1
  global_store_dwordx4 v15, v[36:39], s[88:89]
  s_endpgm
gemm1_kernel_vK0:
  s_barrier
  ds_read_b128 v[16:19], v2 offset:0
  ds_read_b128 v[20:23], v2 offset:2048
  ds_read_b128 v[24:27], v2 offset:4096
  ds_read_b128 v[28:31], v2 offset:6144
  ds_read_b64_tr_b16 v[48:49], v4 offset:0
  ds_read_b64_tr_b16 v[50:51], v4 offset:2048
  ds_read_b64_tr_b16 v[52:53], v4 offset:8192
  ds_read_b64_tr_b16 v[54:55], v4 offset:10240
  ds_read_b64_tr_b16 v[56:57], v4 offset:16384
  ds_read_b64_tr_b16 v[58:59], v4 offset:18432
  ds_read_b64_tr_b16 v[60:61], v4 offset:24576
  ds_read_b64_tr_b16 v[62:63], v4 offset:26624
  ds_read_b64_tr_b16 v[64:65], v4 offset:32768
  ds_read_b64_tr_b16 v[66:67], v4 offset:34816
gemm1_kernel_loopK0:
  s_waitcnt lgkmcnt(4)
  v_mfma_f32_16x16x32_bf16 v[88:91], v[48:51], v[16:19], v[88:91]
  v_mfma_f32_16x16x32_bf16 v[92:95], v[48:51], v[20:23], v[92:95]
  ds_read_b128 v[32:35], v3 offset:0
  v_mfma_f32_16x16x32_bf16 v[96:99], v[48:51], v[24:27], v[96:99]
  v_mfma_f32_16x16x32_bf16 v[100:103], v[48:51], v[28:31], v[100:103]
  v_mfma_f32_16x16x32_bf16 v[68:71], v[48:51], v[8:11], v[68:71]
  ds_read_b64_tr_b16 v[48:49], v4 offset:4096
  ds_read_b64_tr_b16 v[50:51], v4 offset:6144
  v_mfma_f32_16x16x32_bf16 v[104:107], v[52:55], v[16:19], v[104:107]
  v_mfma_f32_16x16x32_bf16 v[108:111], v[52:55], v[20:23], v[108:111]
  ds_read_b128 v[36:39], v3 offset:2048
  v_mfma_f32_16x16x32_bf16 v[112:115], v[52:55], v[24:27], v[112:115]
  v_mfma_f32_16x16x32_bf16 v[116:119], v[52:55], v[28:31], v[116:119]
  v_mfma_f32_16x16x32_bf16 v[72:75], v[52:55], v[8:11], v[72:75]
  ds_read_b64_tr_b16 v[52:53], v4 offset:12288
  ds_read_b64_tr_b16 v[54:55], v4 offset:14336
  v_mfma_f32_16x16x32_bf16 v[120:123], v[56:59], v[16:19], v[120:123]
  v_mfma_f32_16x16x32_bf16 v[124:127], v[56:59], v[20:23], v[124:127]
  ds_read_b128 v[40:43], v3 offset:4096
  v_mfma_f32_16x16x32_bf16 v[128:131], v[56:59], v[24:27], v[128:131]
  v_mfma_f32_16x16x32_bf16 v[132:135], v[56:59], v[28:31], v[132:135]
  v_mfma_f32_16x16x32_bf16 v[76:79], v[56:59], v[8:11], v[76:79]
  ds_read_b64_tr_b16 v[56:57], v4 offset:20480
  ds_read_b64_tr_b16 v[58:59], v4 offset:22528
  s_waitcnt lgkmcnt(11)
  v_mfma_f32_16x16x32_bf16 v[136:139], v[60:63], v[16:19], v[136:139]
  v_mfma_f32_16x16x32_bf16 v[140:143], v[60:63], v[20:23], v[140:143]
  ds_read_b128 v[44:47], v3 offset:6144
  v_mfma_f32_16x16x32_bf16 v[144:147], v[60:63], v[24:27], v[144:147]
  v_mfma_f32_16x16x32_bf16 v[148:151], v[60:63], v[28:31], v[148:151]
  v_mfma_f32_16x16x32_bf16 v[80:83], v[60:63], v[8:11], v[80:83]
  ds_read_b64_tr_b16 v[60:61], v4 offset:28672
  ds_read_b64_tr_b16 v[62:63], v4 offset:30720
  s_waitcnt lgkmcnt(12)
  v_mfma_f32_16x16x32_bf16 v[152:155], v[64:67], v[16:19], v[152:155]
  v_mfma_f32_16x16x32_bf16 v[156:159], v[64:67], v[20:23], v[156:159]
  v_mfma_f32_16x16x32_bf16 v[160:163], v[64:67], v[24:27], v[160:163]
  v_mfma_f32_16x16x32_bf16 v[164:167], v[64:67], v[28:31], v[164:167]
  v_mfma_f32_16x16x32_bf16 v[84:87], v[64:67], v[8:11], v[84:87]
  ds_read_b64_tr_b16 v[64:65], v4 offset:36864
  ds_read_b64_tr_b16 v[66:67], v4 offset:38912
  s_add_u32 s44, s42, 40960
  s_cmp_eq_u32 s44, 122880
  s_cselect_b32 s44, 0, s44
  s_sub_u32 s45, s44, s42
  s_mov_b32 s42, s44
  s_waitcnt lgkmcnt(0)
  v_xor_b32 v2, 16384, v2
  v_xor_b32 v3, 16384, v3
  v_add_u32 v4, s45, v4
  s_barrier

  s_waitcnt lgkmcnt(4)
  v_mfma_f32_16x16x32_bf16 v[88:91], v[48:51], v[32:35], v[88:91]
  v_mfma_f32_16x16x32_bf16 v[92:95], v[48:51], v[36:39], v[92:95]
  ds_read_b128 v[16:19], v2 offset:0
  v_mfma_f32_16x16x32_bf16 v[96:99], v[48:51], v[40:43], v[96:99]
  v_mfma_f32_16x16x32_bf16 v[100:103], v[48:51], v[44:47], v[100:103]
  ds_read_b64_tr_b16 v[48:49], v4 offset:0
  ds_read_b64_tr_b16 v[50:51], v4 offset:2048
  v_mfma_f32_16x16x32_bf16 v[104:107], v[52:55], v[32:35], v[104:107]
  v_mfma_f32_16x16x32_bf16 v[108:111], v[52:55], v[36:39], v[108:111]
  ds_read_b128 v[20:23], v2 offset:2048
  v_mfma_f32_16x16x32_bf16 v[112:115], v[52:55], v[40:43], v[112:115]
  v_mfma_f32_16x16x32_bf16 v[116:119], v[52:55], v[44:47], v[116:119]
  ds_read_b64_tr_b16 v[52:53], v4 offset:8192
  ds_read_b64_tr_b16 v[54:55], v4 offset:10240
  v_mfma_f32_16x16x32_bf16 v[120:123], v[56:59], v[32:35], v[120:123]
  v_mfma_f32_16x16x32_bf16 v[124:127], v[56:59], v[36:39], v[124:127]
  ds_read_b128 v[24:27], v2 offset:4096
  v_mfma_f32_16x16x32_bf16 v[128:131], v[56:59], v[40:43], v[128:131]
  v_mfma_f32_16x16x32_bf16 v[132:135], v[56:59], v[44:47], v[132:135]
  ds_read_b64_tr_b16 v[56:57], v4 offset:16384
  ds_read_b64_tr_b16 v[58:59], v4 offset:18432
  s_waitcnt lgkmcnt(11)
  v_mfma_f32_16x16x32_bf16 v[136:139], v[60:63], v[32:35], v[136:139]
  v_mfma_f32_16x16x32_bf16 v[140:143], v[60:63], v[36:39], v[140:143]
  ds_read_b128 v[28:31], v2 offset:6144
  v_mfma_f32_16x16x32_bf16 v[144:147], v[60:63], v[40:43], v[144:147]
  v_mfma_f32_16x16x32_bf16 v[148:151], v[60:63], v[44:47], v[148:151]
  ds_read_b64_tr_b16 v[60:61], v4 offset:24576
  ds_read_b64_tr_b16 v[62:63], v4 offset:26624
  s_waitcnt lgkmcnt(12)
  v_mfma_f32_16x16x32_bf16 v[152:155], v[64:67], v[32:35], v[152:155]
  v_mfma_f32_16x16x32_bf16 v[156:159], v[64:67], v[36:39], v[156:159]
  v_mfma_f32_16x16x32_bf16 v[160:163], v[64:67], v[40:43], v[160:163]
  v_mfma_f32_16x16x32_bf16 v[164:167], v[64:67], v[44:47], v[164:167]
  ds_read_b64_tr_b16 v[64:65], v4 offset:32768
  ds_read_b64_tr_b16 v[66:67], v4 offset:34816
  s_add_u32 s40, s40, 1
  s_cmp_lt_u32 s40, 8
  s_cbranch_scc1 gemm1_kernel_loopK0
  s_waitcnt lgkmcnt(0)
  s_branch gemm1_kernel_epiK

gemm1_kernel_vK1:
  s_barrier
  ds_read_b128 v[16:19], v2 offset:0
  ds_read_b128 v[20:23], v2 offset:2048
  ds_read_b128 v[24:27], v2 offset:4096
  ds_read_b128 v[28:31], v2 offset:6144
  ds_read_b64_tr_b16 v[48:49], v4 offset:0
  ds_read_b64_tr_b16 v[50:51], v4 offset:2048
  ds_read_b64_tr_b16 v[52:53], v4 offset:8192
  ds_read_b64_tr_b16 v[54:55], v4 offset:10240
  ds_read_b64_tr_b16 v[56:57], v4 offset:16384
  ds_read_b64_tr_b16 v[58:59], v4 offset:18432
  ds_read_b64_tr_b16 v[60:61], v4 offset:24576
  ds_read_b64_tr_b16 v[62:63], v4 offset:26624
  ds_read_b64_tr_b16 v[64:65], v4 offset:32768
  ds_read_b64_tr_b16 v[66:67], v4 offset:34816
gemm1_kernel_loopK1:
  s_waitcnt lgkmcnt(4)
  v_mfma_f32_16x16x32_bf16 v[88:91], v[48:51], v[16:19], v[88:91]
  v_mfma_f32_16x16x32_bf16 v[92:95], v[48:51], v[20:23], v[92:95]
  ds_read_b128 v[32:35], v3 offset:0
  v_mfma_f32_16x16x32_bf16 v[96:99], v[48:51], v[24:27], v[96:99]
  v_mfma_f32_16x16x32_bf16 v[100:103], v[48:51], v[28:31], v[100:103]
  ds_read_b64_tr_b16 v[48:49], v4 offset:4096
  ds_read_b64_tr_b16 v[50:51], v4 offset:6144
  v_mfma_f32_16x16x32_bf16 v[104:107], v[52:55], v[16:19], v[104:107]
  v_mfma_f32_16x16x32_bf16 v[108:111], v[52:55], v[20:23], v[108:111]
  ds_read_b128 v[36:39], v3 offset:2048
  v_mfma_f32_16x16x32_bf16 v[112:115], v[52:55], v[24:27], v[112:115]
  v_mfma_f32_16x16x32_bf16 v[116:119], v[52:55], v[28:31], v[116:119]
  ds_read_b64_tr_b16 v[52:53], v4 offset:12288
  ds_read_b64_tr_b16 v[54:55], v4 offset:14336
  v_mfma_f32_16x16x32_bf16 v[120:123], v[56:59], v[16:19], v[120:123]
  v_mfma_f32_16x16x32_bf16 v[124:127], v[56:59], v[20:23], v[124:127]
  ds_read_b128 v[40:43], v3 offset:4096
  v_mfma_f32_16x16x32_bf16 v[128:131], v[56:59], v[24:27], v[128:131]
  v_mfma_f32_16x16x32_bf16 v[132:135], v[56:59], v[28:31], v[132:135]
  ds_read_b64_tr_b16 v[56:57], v4 offset:20480
  ds_read_b64_tr_b16 v[58:59], v4 offset:22528
  s_waitcnt lgkmcnt(11)
  v_mfma_f32_16x16x32_bf16 v[136:139], v[60:63], v[16:19], v[136:139]
  v_mfma_f32_16x16x32_bf16 v[140:143], v[60:63], v[20:23], v[140:143]
  ds_read_b128 v[44:47], v3 offset:6144
  v_mfma_f32_16x16x32_bf16 v[144:147], v[60:63], v[24:27], v[144:147]
  v_mfma_f32_16x16x32_bf16 v[148:151], v[60:63], v[28:31], v[148:151]
  ds_read_b64_tr_b16 v[60:61], v4 offset:28672
  ds_read_b64_tr_b16 v[62:63], v4 offset:30720
  s_waitcnt lgkmcnt(12)
  v_mfma_f32_16x16x32_bf16 v[152:155], v[64:67], v[16:19], v[152:155]
  v_mfma_f32_16x16x32_bf16 v[156:159], v[64:67], v[20:23], v[156:159]
  v_mfma_f32_16x16x32_bf16 v[160:163], v[64:67], v[24:27], v[160:163]
  v_mfma_f32_16x16x32_bf16 v[164:167], v[64:67], v[28:31], v[164:167]
  ds_read_b64_tr_b16 v[64:65], v4 offset:36864
  ds_read_b64_tr_b16 v[66:67], v4 offset:38912
  s_add_u32 s44, s42, 40960
  s_cmp_eq_u32 s44, 122880
  s_cselect_b32 s44, 0, s44
  s_sub_u32 s45, s44, s42
  s_mov_b32 s42, s44
  s_waitcnt lgkmcnt(0)
  v_xor_b32 v2, 16384, v2
  v_xor_b32 v3, 16384, v3
  v_add_u32 v4, s45, v4
  s_barrier

  s_waitcnt lgkmcnt(4)
  v_mfma_f32_16x16x32_bf16 v[88:91], v[48:51], v[32:35], v[88:91]
  v_mfma_f32_16x16x32_bf16 v[92:95], v[48:51], v[36:39], v[92:95]
  ds_read_b128 v[16:19], v2 offset:0
  v_mfma_f32_16x16x32_bf16 v[96:99], v[48:51], v[40:43], v[96:99]
  v_mfma_f32_16x16x32_bf16 v[100:103], v[48:51], v[44:47], v[100:103]
  v_mfma_f32_16x16x32_bf16 v[68:71], v[48:51], v[8:11], v[68:71]
  ds_read_b64_tr_b16 v[48:49], v4 offset:0
  ds_read_b64_tr_b16 v[50:51], v4 offset:2048
  v_mfma_f32_16x16x32_bf16 v[104:107], v[52:55], v[32:35], v[104:107]
  v_mfma_f32_16x16x32_bf16 v[108:111], v[52:55], v[36:39], v[108:111]
  ds_read_b128 v[20:23], v2 offset:2048
  v_mfma_f32_16x16x32_bf16 v[112:115], v[52:55], v[40:43], v[112:115]
  v_mfma_f32_16x16x32_bf16 v[116:119], v[52:55], v[44:47], v[116:119]
  v_mfma_f32_16x16x32_bf16 v[72:75], v[52:55], v[8:11], v[72:75]
  ds_read_b64_tr_b16 v[52:53], v4 offset:8192
  ds_read_b64_tr_b16 v[54:55], v4 offset:10240
  v_mfma_f32_16x16x32_bf16 v[120:123], v[56:59], v[32:35], v[120:123]
  v_mfma_f32_16x16x32_bf16 v[124:127], v[56:59], v[36:39], v[124:127]
  ds_read_b128 v[24:27], v2 offset:4096
  v_mfma_f32_16x16x32_bf16 v[128:131], v[56:59], v[40:43], v[128:131]
  v_mfma_f32_16x16x32_bf16 v[132:135], v[56:59], v[44:47], v[132:135]
  v_mfma_f32_16x16x32_bf16 v[76:79], v[56:59], v[8:11], v[76:79]
  ds_read_b64_tr_b16 v[56:57], v4 offset:16384
  ds_read_b64_tr_b16 v[58:59], v4 offset:18432
  s_waitcnt lgkmcnt(11)
  v_mfma_f32_16x16x32_bf16 v[136:139], v[60:63], v[32:35], v[136:139]
  v_mfma_f32_16x16x32_bf16 v[140:143], v[60:63], v[36:39], v[140:143]
  ds_read_b128 v[28:31], v2 offset:6144
  v_mfma_f32_16x16x32_bf16 v[144:147], v[60:63], v[40:43], v[144:147]
  v_mfma_f32_16x16x32_bf16 v[148:151], v[60:63], v[44:47], v[148:151]
  v_mfma_f32_16x16x32_bf16 v[80:83], v[60:63], v[8:11], v[80:83]
  ds_read_b64_tr_b16 v[60:61], v4 offset:24576
  ds_read_b64_tr_b16 v[62:63], v4 offset:26624
  s_waitcnt lgkmcnt(12)
  v_mfma_f32_16x16x32_bf16 v[152:155], v[64:67], v[32:35], v[152:155]
  v_mfma_f32_16x16x32_bf16 v[156:159], v[64:67], v[36:39], v[156:159]
  v_mfma_f32_16x16x32_bf16 v[160:163], v[64:67], v[40:43], v[160:163]
  v_mfma_f32_16x16x32_bf16 v[164:167], v[64:67], v[44:47], v[164:167]
  v_mfma_f32_16x16x32_bf16 v[84:87], v[64:67], v[8:11], v[84:87]
  ds_read_b64_tr_b16 v[64:65], v4 offset:32768
  ds_read_b64_tr_b16 v[66:67], v4 offset:34816
  s_add_u32 s40, s40, 1
  s_cmp_lt_u32 s40, 8
  s_cbranch_scc1 gemm1_kernel_loopK1
  s_waitcnt lgkmcnt(0)
  s_branch gemm1_kernel_epiK

gemm1_kernel_epiK:
  s_nop 7
  s_nop 3
  s_and_b32 s16, s14, 1
  s_mul_i32 s16, s16, 1280
  s_lshr_b32 s15, s14, 1
  s_lshl_b32 s17, s15, 6
  s_add_u32 s16, s16, s17
  s_add_u32 s16, s16, 156672
  v_lshrrev_b32 v6, 4, v1
  v_lshl_add_u32 v16, v6, 4, s16

  ds_write_b128 v16, v[68:71] offset:0
  ds_write_b128 v16, v[72:75] offset:256
  ds_write_b128 v16, v[76:79] offset:512
  ds_write_b128 v16, v[80:83] offset:768
  ds_write_b128 v16, v[84:87] offset:1024
  s_waitcnt lgkmcnt(0)
  s_barrier
  s_and_b32 s30, s14, 1
  s_lshl_b32 s30, s30, 6
  s_lshl_b32 s31, s12, 7
  s_add_u32 s30, s30, s31
  v_and_b32 v5, 15, v1
  s_mov_b32 s40, 0xc0135761
  s_mov_b32 s41, 0xbdd2d3e8
  s_mov_b32 s42, 0x3eb8aa3b

  s_and_b32 s16, s14, 1
  s_lshl_b32 s16, s16, 8
  s_add_u32 s16, s16, 155648
  v_lshl_add_u32 v16, v5, 2, s16
  s_lshl_b32 s17, s15, 6
  s_add_u32 s17, s17, 156672
  v_lshl_add_u32 v17, v6, 4, s17

  ds_read_b32 v56, v16 offset:0
  ds_read_b32 v60, v16 offset:512
  ds_read_b32 v57, v16 offset:64
  ds_read_b32 v61, v16 offset:576
  ds_read_b32 v58, v16 offset:128
  ds_read_b32 v62, v16 offset:640
  ds_read_b32 v59, v16 offset:192
  ds_read_b32 v63, v16 offset:704
  ds_read_b128 v[64:67], v17 offset:0
  ds_read_b128 v[20:23], v17 offset:1280
  ds_read_b128 v[68:71], v17 offset:256
  ds_read_b128 v[24:27], v17 offset:1536
  ds_read_b128 v[72:75], v17 offset:512
  ds_read_b128 v[28:31], v17 offset:1792
  ds_read_b128 v[76:79], v17 offset:768
  ds_read_b128 v[32:35], v17 offset:2048
  ds_read_b128 v[80:83], v17 offset:1024
  ds_read_b128 v[36:39], v17 offset:2304
  s_waitcnt lgkmcnt(0)
  v_add_f32 v64, v64, v20
  v_add_f32 v65, v65, v21
  v_add_f32 v66, v66, v22
  v_add_f32 v67, v67, v23
  v_add_f32 v68, v68, v24
  v_add_f32 v69, v69, v25
  v_add_f32 v70, v70, v26
  v_add_f32 v71, v71, v27
  v_add_f32 v72, v72, v28
  v_add_f32 v73, v73, v29
  v_add_f32 v74, v74, v30
  v_add_f32 v75, v75, v31
  v_add_f32 v76, v76, v32
  v_add_f32 v77, v77, v33
  v_add_f32 v78, v78, v34
  v_add_f32 v79, v79, v35
  v_add_f32 v80, v80, v36
  v_add_f32 v81, v81, v37
  v_add_f32 v82, v82, v38
  v_add_f32 v83, v83, v39
  v_fma_f32 v88, v60, v64, v88
  v_fma_f32 v89, v60, v65, v89
  v_fma_f32 v90, v60, v66, v90
  v_fma_f32 v91, v60, v67, v91
  v_mul_f32 v88, v56, v88
  v_mul_f32 v89, v56, v89
  v_mul_f32 v90, v56, v90
  v_mul_f32 v91, v56, v91
  v_fma_f32 v92, v61, v64, v92
  v_fma_f32 v93, v61, v65, v93
  v_fma_f32 v94, v61, v66, v94
  v_fma_f32 v95, v61, v67, v95
  v_mul_f32 v92, v57, v92
  v_mul_f32 v93, v57, v93
  v_mul_f32 v94, v57, v94
  v_mul_f32 v95, v57, v95
  v_fma_f32 v96, v62, v64, v96
  v_fma_f32 v97, v62, v65, v97
  v_fma_f32 v98, v62, v66, v98
  v_fma_f32 v99, v62, v67, v99
  v_mul_f32 v96, v58, v96
  v_mul_f32 v97, v58, v97
  v_mul_f32 v98, v58, v98
  v_mul_f32 v99, v58, v99
  v_fma_f32 v100, v63, v64, v100
  v_fma_f32 v101, v63, v65, v101
  v_fma_f32 v102, v63, v66, v102
  v_fma_f32 v103, v63, v67, v103
  v_mul_f32 v100, v59, v100
  v_mul_f32 v101, v59, v101
  v_mul_f32 v102, v59, v102
  v_mul_f32 v103, v59, v103
  v_fma_f32 v104, v60, v68, v104
  v_fma_f32 v105, v60, v69, v105
  v_fma_f32 v106, v60, v70, v106
  v_fma_f32 v107, v60, v71, v107
  v_mul_f32 v104, v56, v104
  v_mul_f32 v105, v56, v105
  v_mul_f32 v106, v56, v106
  v_mul_f32 v107, v56, v107
  v_fma_f32 v108, v61, v68, v108
  v_fma_f32 v109, v61, v69, v109
  v_fma_f32 v110, v61, v70, v110
  v_fma_f32 v111, v61, v71, v111
  v_mul_f32 v108, v57, v108
  v_mul_f32 v109, v57, v109
  v_mul_f32 v110, v57, v110
  v_mul_f32 v111, v57, v111
  v_fma_f32 v112, v62, v68, v112
  v_fma_f32 v113, v62, v69, v113
  v_fma_f32 v114, v62, v70, v114
  v_fma_f32 v115, v62, v71, v115
  v_mul_f32 v112, v58, v112
  v_mul_f32 v113, v58, v113
  v_mul_f32 v114, v58, v114
  v_mul_f32 v115, v58, v115
  v_fma_f32 v116, v63, v68, v116
  v_fma_f32 v117, v63, v69, v117
  v_fma_f32 v118, v63, v70, v118
  v_fma_f32 v119, v63, v71, v119
  v_mul_f32 v116, v59, v116
  v_mul_f32 v117, v59, v117
  v_mul_f32 v118, v59, v118
  v_mul_f32 v119, v59, v119
  v_fma_f32 v120, v60, v72, v120
  v_fma_f32 v121, v60, v73, v121
  v_fma_f32 v122, v60, v74, v122
  v_fma_f32 v123, v60, v75, v123
  v_mul_f32 v120, v56, v120
  v_mul_f32 v121, v56, v121
  v_mul_f32 v122, v56, v122
  v_mul_f32 v123, v56, v123
  v_fma_f32 v124, v61, v72, v124
  v_fma_f32 v125, v61, v73, v125
  v_fma_f32 v126, v61, v74, v126
  v_fma_f32 v127, v61, v75, v127
  v_mul_f32 v124, v57, v124
  v_mul_f32 v125, v57, v125
  v_mul_f32 v126, v57, v126
  v_mul_f32 v127, v57, v127
  v_fma_f32 v128, v62, v72, v128
  v_fma_f32 v129, v62, v73, v129
  v_fma_f32 v130, v62, v74, v130
  v_fma_f32 v131, v62, v75, v131
  v_mul_f32 v128, v58, v128
  v_mul_f32 v129, v58, v129
  v_mul_f32 v130, v58, v130
  v_mul_f32 v131, v58, v131
  v_fma_f32 v132, v63, v72, v132
  v_fma_f32 v133, v63, v73, v133
  v_fma_f32 v134, v63, v74, v134
  v_fma_f32 v135, v63, v75, v135
  v_mul_f32 v132, v59, v132
  v_mul_f32 v133, v59, v133
  v_mul_f32 v134, v59, v134
  v_mul_f32 v135, v59, v135
  v_fma_f32 v136, v60, v76, v136
  v_fma_f32 v137, v60, v77, v137
  v_fma_f32 v138, v60, v78, v138
  v_fma_f32 v139, v60, v79, v139
  v_mul_f32 v136, v56, v136
  v_mul_f32 v137, v56, v137
  v_mul_f32 v138, v56, v138
  v_mul_f32 v139, v56, v139
  v_fma_f32 v140, v61, v76, v140
  v_fma_f32 v141, v61, v77, v141
  v_fma_f32 v142, v61, v78, v142
  v_fma_f32 v143, v61, v79, v143
  v_mul_f32 v140, v57, v140
  v_mul_f32 v141, v57, v141
  v_mul_f32 v142, v57, v142
  v_mul_f32 v143, v57, v143
  v_fma_f32 v144, v62, v76, v144
  v_fma_f32 v145, v62, v77, v145
  v_fma_f32 v146, v62, v78, v146
  v_fma_f32 v147, v62, v79, v147
  v_mul_f32 v144, v58, v144
  v_mul_f32 v145, v58, v145
  v_mul_f32 v146, v58, v146
  v_mul_f32 v147, v58, v147
  v_fma_f32 v148, v63, v76, v148
  v_fma_f32 v149, v63, v77, v149
  v_fma_f32 v150, v63, v78, v150
  v_fma_f32 v151, v63, v79, v151
  v_mul_f32 v148, v59, v148
  v_mul_f32 v149, v59, v149
  v_mul_f32 v150, v59, v150
  v_mul_f32 v151, v59, v151
  v_fma_f32 v152, v60, v80, v152
  v_fma_f32 v153, v60, v81, v153
  v_fma_f32 v154, v60, v82, v154
  v_fma_f32 v155, v60, v83, v155
  v_mul_f32 v152, v56, v152
  v_mul_f32 v153, v56, v153
  v_mul_f32 v154, v56, v154
  v_mul_f32 v155, v56, v155
  v_fma_f32 v156, v61, v80, v156
  v_fma_f32 v157, v61, v81, v157
  v_fma_f32 v158, v61, v82, v158
  v_fma_f32 v159, v61, v83, v159
  v_mul_f32 v156, v57, v156
  v_mul_f32 v157, v57, v157
  v_mul_f32 v158, v57, v158
  v_mul_f32 v159, v57, v159
  v_fma_f32 v160, v62, v80, v160
  v_fma_f32 v161, v62, v81, v161
  v_fma_f32 v162, v62, v82, v162
  v_fma_f32 v163, v62, v83, v163
  v_mul_f32 v160, v58, v160
  v_mul_f32 v161, v58, v161
  v_mul_f32 v162, v58, v162
  v_mul_f32 v163, v58, v163
  v_fma_f32 v164, v63, v80, v164
  v_fma_f32 v165, v63, v81, v165
  v_fma_f32 v166, v63, v82, v166
  v_fma_f32 v167, v63, v83, v167
  v_mul_f32 v164, v59, v164
  v_mul_f32 v165, v59, v165
  v_mul_f32 v166, v59, v166
  v_mul_f32 v167, v59, v167
  v_lshlrev_b32 v13, 4, v5
  v_lshrrev_b32 v7, 1, v6
  v_lshl_add_u32 v13, v7, 9, v13
  v_and_b32 v12, 1, v6
  v_lshl_add_u32 v13, v12, 3, v13
  v_lshlrev_b32 v14, 4, v5
  v_lshl_add_u32 v14, v12, 8, v14
  v_lshl_add_u32 v14, v7, 3, v14
  s_lshl_b32 s34, s30, 5

  s_sub_u32 s35, s13, 8
  s_lshl_b32 s35, s35, 2
  s_add_u32 s35, s35, s15
  s_lshl_b32 s35, s35, 16
  s_add_u32 s35, s35, s34
  s_add_u32 s35, s35, 4194304
  s_add_u32 s36, s4, s35
  s_addc_u32 s37, s5, 0

  v_cvt_pk_bf16_f32 v40, v152, v153
  v_cvt_pk_bf16_f32 v41, v154, v155
  global_store_dwordx2 v13, v[40:41], s[36:37] offset:0
  v_cvt_pk_bf16_f32 v42, v156, v157
  v_cvt_pk_bf16_f32 v43, v158, v159
  global_store_dwordx2 v13, v[42:43], s[36:37] offset:256
  v_cvt_pk_bf16_f32 v44, v160, v161
  v_cvt_pk_bf16_f32 v45, v162, v163
  global_store_dwordx2 v13, v[44:45], s[36:37] offset:1024
  v_cvt_pk_bf16_f32 v46, v164, v165
  v_cvt_pk_bf16_f32 v47, v166, v167
  global_store_dwordx2 v13, v[46:47], s[36:37] offset:1280
  s_lshr_b32 s32, s30, 5
  s_mul_i32 s32, s32, 112
  s_lshl_b32 s33, s13, 3
  s_add_u32 s32, s32, s33
  s_add_u32 s32, s32, s15
  s_lshl_b32 s32, s32, 10
  s_add_u32 s32, s32, 8388608
  s_add_u32 s32, s4, s32
  s_addc_u32 s33, s5, 0
  s_add_u32 s88, s32, 4096
  s_addc_u32 s89, s33, 0
  v_mov_b32 v8, s40

  v_lshlrev_b32 v15, 4, v1
  v_mul_f32 v16, v88, v88
  v_mul_f32 v17, v89, v89
  v_mul_f32 v18, v90, v90
  v_mul_f32 v19, v91, v91
  v_fma_f32 v16, v16, s41, v8
  v_fma_f32 v17, v17, s41, v8
  v_fma_f32 v18, v18, s41, v8
  v_fma_f32 v19, v19, s41, v8
  v_mul_f32 v16, v16, v88
  v_mul_f32 v17, v17, v89
  v_mul_f32 v18, v18, v90
  v_mul_f32 v19, v19, v91
  v_exp_f32 v16, v16
  v_exp_f32 v17, v17
  v_exp_f32 v18, v18
  v_exp_f32 v19, v19
  v_mul_f32 v20, v88, v120
  v_mul_f32 v21, v89, v121
  v_mul_f32 v22, v90, v122
  v_mul_f32 v23, v91, v123
  v_add_f32 v16, 1.0, v16
  v_add_f32 v17, 1.0, v17
  v_add_f32 v18, 1.0, v18
  v_add_f32 v19, 1.0, v19
  v_rcp_f32 v16, v16
  v_rcp_f32 v17, v17
  v_rcp_f32 v18, v18
  v_rcp_f32 v19, v19
  s_nop 0
  v_mul_f32 v16, v16, v20
  v_mul_f32 v17, v17, v21
  v_mul_f32 v18, v18, v22
  v_mul_f32 v19, v19, v23
  v_cvt_pk_bf16_f32 v32, v16, v17
  v_cvt_pk_bf16_f32 v33, v18, v19
  v_mul_f32 v16, v92, v92
  v_mul_f32 v17, v93, v93
  v_mul_f32 v18, v94, v94
  v_mul_f32 v19, v95, v95
  v_fma_f32 v16, v16, s41, v8
  v_fma_f32 v17, v17, s41, v8
  v_fma_f32 v18, v18, s41, v8
  v_fma_f32 v19, v19, s41, v8
  v_mul_f32 v16, v16, v92
  v_mul_f32 v17, v17, v93
  v_mul_f32 v18, v18, v94
  v_mul_f32 v19, v19, v95
  v_exp_f32 v16, v16
  v_exp_f32 v17, v17
  v_exp_f32 v18, v18
  v_exp_f32 v19, v19
  v_mul_f32 v20, v92, v124
  v_mul_f32 v21, v93, v125
  v_mul_f32 v22, v94, v126
  v_mul_f32 v23, v95, v127
  v_add_f32 v16, 1.0, v16
  v_add_f32 v17, 1.0, v17
  v_add_f32 v18, 1.0, v18
  v_add_f32 v19, 1.0, v19
  v_rcp_f32 v16, v16
  v_rcp_f32 v17, v17
  v_rcp_f32 v18, v18
  v_rcp_f32 v19, v19
  s_nop 0
  v_mul_f32 v16, v16, v20
  v_mul_f32 v17, v17, v21
  v_mul_f32 v18, v18, v22
  v_mul_f32 v19, v19, v23
  v_cvt_pk_bf16_f32 v34, v16, v17
  v_cvt_pk_bf16_f32 v35, v18, v19
  s_nop 1
  v_permlane16_swap_b32 v32, v34
  v_permlane16_swap_b32 v33, v35
  s_nop 1
  global_store_dwordx4 v15, v[32:35], s[32:33]
  v_mul_f32 v16, v104, v104
  v_mul_f32 v17, v105, v105
  v_mul_f32 v18, v106, v106
  v_mul_f32 v19, v107, v107
  v_fma_f32 v16, v16, s41, v8
  v_fma_f32 v17, v17, s41, v8
  v_fma_f32 v18, v18, s41, v8
  v_fma_f32 v19, v19, s41, v8
  v_mul_f32 v16, v16, v104
  v_mul_f32 v17, v17, v105
  v_mul_f32 v18, v18, v106
  v_mul_f32 v19, v19, v107
  v_exp_f32 v16, v16
  v_exp_f32 v17, v17
  v_exp_f32 v18, v18
  v_exp_f32 v19, v19
  v_mul_f32 v20, v104, v136
  v_mul_f32 v21, v105, v137
  v_mul_f32 v22, v106, v138
  v_mul_f32 v23, v107, v139
  v_add_f32 v16, 1.0, v16
  v_add_f32 v17, 1.0, v17
  v_add_f32 v18, 1.0, v18
  v_add_f32 v19, 1.0, v19
  v_rcp_f32 v16, v16
  v_rcp_f32 v17, v17
  v_rcp_f32 v18, v18
  v_rcp_f32 v19, v19
  s_nop 0
  v_mul_f32 v16, v16, v20
  v_mul_f32 v17, v17, v21
  v_mul_f32 v18, v18, v22
  v_mul_f32 v19, v19, v23
  v_cvt_pk_bf16_f32 v36, v16, v17
  v_cvt_pk_bf16_f32 v37, v18, v19
  v_mul_f32 v16, v108, v108
  v_mul_f32 v17, v109, v109
  v_mul_f32 v18, v110, v110
  v_mul_f32 v19, v111, v111
  v_fma_f32 v16, v16, s41, v8
  v_fma_f32 v17, v17, s41, v8
  v_fma_f32 v18, v18, s41, v8
  v_fma_f32 v19, v19, s41, v8
  v_mul_f32 v16, v16, v108
  v_mul_f32 v17, v17, v109
  v_mul_f32 v18, v18, v110
  v_mul_f32 v19, v19, v111
  v_exp_f32 v16, v16
  v_exp_f32 v17, v17
  v_exp_f32 v18, v18
  v_exp_f32 v19, v19
  v_mul_f32 v20, v108, v140
  v_mul_f32 v21, v109, v141
  v_mul_f32 v22, v110, v142
  v_mul_f32 v23, v111, v143
  v_add_f32 v16, 1.0, v16
  v_add_f32 v17, 1.0, v17
  v_add_f32 v18, 1.0, v18
  v_add_f32 v19, 1.0, v19
  v_rcp_f32 v16, v16
  v_rcp_f32 v17, v17
  v_rcp_f32 v18, v18
  v_rcp_f32 v19, v19
  s_nop 0
  v_mul_f32 v16, v16, v20
  v_mul_f32 v17, v17, v21
  v_mul_f32 v18, v18, v22
  v_mul_f32 v19, v19, v23
  v_cvt_pk_bf16_f32 v38, v16, v17
  v_cvt_pk_bf16_f32 v39, v18, v19
  s_nop 1
  v_permlane16_swap_b32 v36, v38
  v_permlane16_swap_b32 v37, v39
  s_nop 1
  global_store_dwordx4 v15, v[36:39], s[88:89]
  s_add_u32 s32, s32, 114688
  s_addc_u32 s33, s33, 0
  s_add_u32 s88, s88, 114688
  s_addc_u32 s89, s89, 0
  v_mul_f32 v16, v96, v96
  v_mul_f32 v17, v97, v97
  v_mul_f32 v18, v98, v98
  v_mul_f32 v19, v99, v99
  v_fma_f32 v16, v16, s41, v8
  v_fma_f32 v17, v17, s41, v8
  v_fma_f32 v18, v18, s41, v8
  v_fma_f32 v19, v19, s41, v8
  v_mul_f32 v16, v16, v96
  v_mul_f32 v17, v17, v97
  v_mul_f32 v18, v18, v98
  v_mul_f32 v19, v19, v99
  v_exp_f32 v16, v16
  v_exp_f32 v17, v17
  v_exp_f32 v18, v18
  v_exp_f32 v19, v19
  v_mul_f32 v20, v96, v128
  v_mul_f32 v21, v97, v129
  v_mul_f32 v22, v98, v130
  v_mul_f32 v23, v99, v131
  v_add_f32 v16, 1.0, v16
  v_add_f32 v17, 1.0, v17
  v_add_f32 v18, 1.0, v18
  v_add_f32 v19, 1.0, v19
  v_rcp_f32 v16, v16
  v_rcp_f32 v17, v17
  v_rcp_f32 v18, v18
  v_rcp_f32 v19, v19
  s_nop 0
  v_mul_f32 v16, v16, v20
  v_mul_f32 v17, v17, v21
  v_mul_f32 v18, v18, v22
  v_mul_f32 v19, v19, v23
  v_cvt_pk_bf16_f32 v32, v16, v17
  v_cvt_pk_bf16_f32 v33, v18, v19
  v_mul_f32 v16, v100, v100
  v_mul_f32 v17, v101, v101
  v_mul_f32 v18, v102, v102
  v_mul_f32 v19, v103, v103
  v_fma_f32 v16, v16, s41, v8
  v_fma_f32 v17, v17, s41, v8
  v_fma_f32 v18, v18, s41, v8
  v_fma_f32 v19, v19, s41, v8
  v_mul_f32 v16, v16, v100
  v_mul_f32 v17, v17, v101
  v_mul_f32 v18, v18, v102
  v_mul_f32 v19, v19, v103
  v_exp_f32 v16, v16
  v_exp_f32 v17, v17
  v_exp_f32 v18, v18
  v_exp_f32 v19, v19
  v_mul_f32 v20, v100, v132
  v_mul_f32 v21, v101, v133
  v_mul_f32 v22, v102, v134
  v_mul_f32 v23, v103, v135
  v_add_f32 v16, 1.0, v16
  v_add_f32 v17, 1.0, v17
  v_add_f32 v18, 1.0, v18
  v_add_f32 v19, 1.0, v19
  v_rcp_f32 v16, v16
  v_rcp_f32 v17, v17
  v_rcp_f32 v18, v18
  v_rcp_f32 v19, v19
  s_nop 0
  v_mul_f32 v16, v16, v20
  v_mul_f32 v17, v17, v21
  v_mul_f32 v18, v18, v22
  v_mul_f32 v19, v19, v23
  v_cvt_pk_bf16_f32 v34, v16, v17
  v_cvt_pk_bf16_f32 v35, v18, v19
  s_nop 1
  v_permlane16_swap_b32 v32, v34
  v_permlane16_swap_b32 v33, v35
  s_nop 1
  global_store_dwordx4 v15, v[32:35], s[32:33]
  v_mul_f32 v16, v112, v112
  v_mul_f32 v17, v113, v113
  v_mul_f32 v18, v114, v114
  v_mul_f32 v19, v115, v115
  v_fma_f32 v16, v16, s41, v8
  v_fma_f32 v17, v17, s41, v8
  v_fma_f32 v18, v18, s41, v8
  v_fma_f32 v19, v19, s41, v8
  v_mul_f32 v16, v16, v112
  v_mul_f32 v17, v17, v113
  v_mul_f32 v18, v18, v114
  v_mul_f32 v19, v19, v115
  v_exp_f32 v16, v16
  v_exp_f32 v17, v17
  v_exp_f32 v18, v18
  v_exp_f32 v19, v19
  v_mul_f32 v20, v112, v144
  v_mul_f32 v21, v113, v145
  v_mul_f32 v22, v114, v146
  v_mul_f32 v23, v115, v147
  v_add_f32 v16, 1.0, v16
  v_add_f32 v17, 1.0, v17
  v_add_f32 v18, 1.0, v18
  v_add_f32 v19, 1.0, v19
  v_rcp_f32 v16, v16
  v_rcp_f32 v17, v17
  v_rcp_f32 v18, v18
  v_rcp_f32 v19, v19
  s_nop 0
  v_mul_f32 v16, v16, v20
  v_mul_f32 v17, v17, v21
  v_mul_f32 v18, v18, v22
  v_mul_f32 v19, v19, v23
  v_cvt_pk_bf16_f32 v36, v16, v17
  v_cvt_pk_bf16_f32 v37, v18, v19
  v_mul_f32 v16, v116, v116
  v_mul_f32 v17, v117, v117
  v_mul_f32 v18, v118, v118
  v_mul_f32 v19, v119, v119
  v_fma_f32 v16, v16, s41, v8
  v_fma_f32 v17, v17, s41, v8
  v_fma_f32 v18, v18, s41, v8
  v_fma_f32 v19, v19, s41, v8
  v_mul_f32 v16, v16, v116
  v_mul_f32 v17, v17, v117
  v_mul_f32 v18, v18, v118
  v_mul_f32 v19, v19, v119
  v_exp_f32 v16, v16
  v_exp_f32 v17, v17
  v_exp_f32 v18, v18
  v_exp_f32 v19, v19
  v_mul_f32 v20, v116, v148
  v_mul_f32 v21, v117, v149
  v_mul_f32 v22, v118, v150
  v_mul_f32 v23, v119, v151
  v_add_f32 v16, 1.0, v16
  v_add_f32 v17, 1.0, v17
  v_add_f32 v18, 1.0, v18
  v_add_f32 v19, 1.0, v19
  v_rcp_f32 v16, v16
  v_rcp_f32 v17, v17
  v_rcp_f32 v18, v18
  v_rcp_f32 v19, v19
  s_nop 0
  v_mul_f32 v16, v16, v20
  v_mul_f32 v17, v17, v21
  v_mul_f32 v18, v18, v22
  v_mul_f32 v19, v19, v23
  v_cvt_pk_bf16_f32 v38, v16, v17
  v_cvt_pk_bf16_f32 v39, v18, v19
  s_nop 1
  v_permlane16_swap_b32 v36, v38
  v_permlane16_swap_b32 v37, v39
  s_nop 1
  global_store_dwordx4 v15, v[36:39], s[88:89]
  s_endpgm
gemm1_kernel_vB0:
  s_barrier
  ds_read_b128 v[16:19], v2 offset:0
  ds_read_b128 v[20:23], v2 offset:2048
  ds_read_b128 v[24:27], v2 offset:4096
  ds_read_b128 v[28:31], v2 offset:6144
  ds_read_b64_tr_b16 v[48:49], v4 offset:0
  ds_read_b64_tr_b16 v[50:51], v4 offset:2048
  ds_read_b64_tr_b16 v[52:53], v4 offset:8192
  ds_read_b64_tr_b16 v[54:55], v4 offset:10240
  ds_read_b64_tr_b16 v[56:57], v4 offset:16384
  ds_read_b64_tr_b16 v[58:59], v4 offset:18432
  ds_read_b64_tr_b16 v[60:61], v4 offset:24576
  ds_read_b64_tr_b16 v[62:63], v4 offset:26624
  ds_read_b64_tr_b16 v[64:65], v4 offset:32768
  ds_read_b64_tr_b16 v[66:67], v4 offset:34816
gemm1_kernel_loopB0:
  s_waitcnt lgkmcnt(4)
  v_mfma_f32_16x16x32_bf16 v[88:91], v[48:51], v[16:19], v[88:91]
  v_mfma_f32_16x16x32_bf16 v[92:95], v[48:51], v[20:23], v[92:95]
  ds_read_b128 v[32:35], v3 offset:0
  v_mfma_f32_16x16x32_bf16 v[96:99], v[48:51], v[24:27], v[96:99]
  v_mfma_f32_16x16x32_bf16 v[100:103], v[48:51], v[28:31], v[100:103]
  v_mfma_f32_16x16x32_bf16 v[68:71], v[48:51], v[8:11], v[68:71]
  ds_read_b64_tr_b16 v[48:49], v4 offset:4096
  ds_read_b64_tr_b16 v[50:51], v4 offset:6144
  v_mfma_f32_16x16x32_bf16 v[104:107], v[52:55], v[16:19], v[104:107]
  v_mfma_f32_16x16x32_bf16 v[108:111], v[52:55], v[20:23], v[108:111]
  ds_read_b128 v[36:39], v3 offset:2048
  v_mfma_f32_16x16x32_bf16 v[112:115], v[52:55], v[24:27], v[112:115]
  v_mfma_f32_16x16x32_bf16 v[116:119], v[52:55], v[28:31], v[116:119]
  v_mfma_f32_16x16x32_bf16 v[72:75], v[52:55], v[8:11], v[72:75]
  ds_read_b64_tr_b16 v[52:53], v4 offset:12288
  ds_read_b64_tr_b16 v[54:55], v4 offset:14336
  v_mfma_f32_16x16x32_bf16 v[120:123], v[56:59], v[16:19], v[120:123]
  v_mfma_f32_16x16x32_bf16 v[124:127], v[56:59], v[20:23], v[124:127]
  ds_read_b128 v[40:43], v3 offset:4096
  v_mfma_f32_16x16x32_bf16 v[128:131], v[56:59], v[24:27], v[128:131]
  v_mfma_f32_16x16x32_bf16 v[132:135], v[56:59], v[28:31], v[132:135]
  v_mfma_f32_16x16x32_bf16 v[76:79], v[56:59], v[8:11], v[76:79]
  ds_read_b64_tr_b16 v[56:57], v4 offset:20480
  ds_read_b64_tr_b16 v[58:59], v4 offset:22528
  s_waitcnt lgkmcnt(11)
  v_mfma_f32_16x16x32_bf16 v[136:139], v[60:63], v[16:19], v[136:139]
  v_mfma_f32_16x16x32_bf16 v[140:143], v[60:63], v[20:23], v[140:143]
  ds_read_b128 v[44:47], v3 offset:6144
  v_mfma_f32_16x16x32_bf16 v[144:147], v[60:63], v[24:27], v[144:147]
  v_mfma_f32_16x16x32_bf16 v[148:151], v[60:63], v[28:31], v[148:151]
  v_mfma_f32_16x16x32_bf16 v[80:83], v[60:63], v[8:11], v[80:83]
  ds_read_b64_tr_b16 v[60:61], v4 offset:28672
  ds_read_b64_tr_b16 v[62:63], v4 offset:30720
  s_waitcnt lgkmcnt(12)
  v_mfma_f32_16x16x32_bf16 v[152:155], v[64:67], v[16:19], v[152:155]
  v_mfma_f32_16x16x32_bf16 v[156:159], v[64:67], v[20:23], v[156:159]
  v_mfma_f32_16x16x32_bf16 v[160:163], v[64:67], v[24:27], v[160:163]
  v_mfma_f32_16x16x32_bf16 v[164:167], v[64:67], v[28:31], v[164:167]
  v_mfma_f32_16x16x32_bf16 v[84:87], v[64:67], v[8:11], v[84:87]
  ds_read_b64_tr_b16 v[64:65], v4 offset:36864
  ds_read_b64_tr_b16 v[66:67], v4 offset:38912
  s_add_u32 s44, s42, 40960
  s_cmp_eq_u32 s44, 122880
  s_cselect_b32 s44, 0, s44
  s_sub_u32 s45, s44, s42
  s_mov_b32 s42, s44
  s_waitcnt lgkmcnt(0)
  v_xor_b32 v2, 16384, v2
  v_xor_b32 v3, 16384, v3
  v_add_u32 v4, s45, v4
  s_barrier

  s_waitcnt lgkmcnt(4)
  v_mfma_f32_16x16x32_bf16 v[88:91], v[48:51], v[32:35], v[88:91]
  v_mfma_f32_16x16x32_bf16 v[92:95], v[48:51], v[36:39], v[92:95]
  ds_read_b128 v[16:19], v2 offset:0
  v_mfma_f32_16x16x32_bf16 v[96:99], v[48:51], v[40:43], v[96:99]
  v_mfma_f32_16x16x32_bf16 v[100:103], v[48:51], v[44:47], v[100:103]
  ds_read_b64_tr_b16 v[48:49], v4 offset:0
  ds_read_b64_tr_b16 v[50:51], v4 offset:2048
  v_mfma_f32_16x16x32_bf16 v[104:107], v[52:55], v[32:35], v[104:107]
  v_mfma_f32_16x16x32_bf16 v[108:111], v[52:55], v[36:39], v[108:111]
  ds_read_b128 v[20:23], v2 offset:2048
  v_mfma_f32_16x16x32_bf16 v[112:115], v[52:55], v[40:43], v[112:115]
  v_mfma_f32_16x16x32_bf16 v[116:119], v[52:55], v[44:47], v[116:119]
  ds_read_b64_tr_b16 v[52:53], v4 offset:8192
  ds_read_b64_tr_b16 v[54:55], v4 offset:10240
  v_mfma_f32_16x16x32_bf16 v[120:123], v[56:59], v[32:35], v[120:123]
  v_mfma_f32_16x16x32_bf16 v[124:127], v[56:59], v[36:39], v[124:127]
  ds_read_b128 v[24:27], v2 offset:4096
  v_mfma_f32_16x16x32_bf16 v[128:131], v[56:59], v[40:43], v[128:131]
  v_mfma_f32_16x16x32_bf16 v[132:135], v[56:59], v[44:47], v[132:135]
  ds_read_b64_tr_b16 v[56:57], v4 offset:16384
  ds_read_b64_tr_b16 v[58:59], v4 offset:18432
  s_waitcnt lgkmcnt(11)
  v_mfma_f32_16x16x32_bf16 v[136:139], v[60:63], v[32:35], v[136:139]
  v_mfma_f32_16x16x32_bf16 v[140:143], v[60:63], v[36:39], v[140:143]
  ds_read_b128 v[28:31], v2 offset:6144
  v_mfma_f32_16x16x32_bf16 v[144:147], v[60:63], v[40:43], v[144:147]
  v_mfma_f32_16x16x32_bf16 v[148:151], v[60:63], v[44:47], v[148:151]
  ds_read_b64_tr_b16 v[60:61], v4 offset:24576
  ds_read_b64_tr_b16 v[62:63], v4 offset:26624
  s_waitcnt lgkmcnt(12)
  v_mfma_f32_16x16x32_bf16 v[152:155], v[64:67], v[32:35], v[152:155]
  v_mfma_f32_16x16x32_bf16 v[156:159], v[64:67], v[36:39], v[156:159]
  v_mfma_f32_16x16x32_bf16 v[160:163], v[64:67], v[40:43], v[160:163]
  v_mfma_f32_16x16x32_bf16 v[164:167], v[64:67], v[44:47], v[164:167]
  ds_read_b64_tr_b16 v[64:65], v4 offset:32768
  ds_read_b64_tr_b16 v[66:67], v4 offset:34816
  s_add_u32 s40, s40, 1
  s_cmp_lt_u32 s40, 8
  s_cbranch_scc1 gemm1_kernel_loopB0
  s_waitcnt lgkmcnt(0)
  s_branch gemm1_kernel_epiB

gemm1_kernel_vB1:
  s_barrier
  ds_read_b128 v[16:19], v2 offset:0
  ds_read_b128 v[20:23], v2 offset:2048
  ds_read_b128 v[24:27], v2 offset:4096
  ds_read_b128 v[28:31], v2 offset:6144
  ds_read_b64_tr_b16 v[48:49], v4 offset:0
  ds_read_b64_tr_b16 v[50:51], v4 offset:2048
  ds_read_b64_tr_b16 v[52:53], v4 offset:8192
  ds_read_b64_tr_b16 v[54:55], v4 offset:10240
  ds_read_b64_tr_b16 v[56:57], v4 offset:16384
  ds_read_b64_tr_b16 v[58:59], v4 offset:18432
  ds_read_b64_tr_b16 v[60:61], v4 offset:24576
  ds_read_b64_tr_b16 v[62:63], v4 offset:26624
  ds_read_b64_tr_b16 v[64:65], v4 offset:32768
  ds_read_b64_tr_b16 v[66:67], v4 offset:34816
gemm1_kernel_loopB1:
  s_waitcnt lgkmcnt(4)
  v_mfma_f32_16x16x32_bf16 v[88:91], v[48:51], v[16:19], v[88:91]
  v_mfma_f32_16x16x32_bf16 v[92:95], v[48:51], v[20:23], v[92:95]
  ds_read_b128 v[32:35], v3 offset:0
  v_mfma_f32_16x16x32_bf16 v[96:99], v[48:51], v[24:27], v[96:99]
  v_mfma_f32_16x16x32_bf16 v[100:103], v[48:51], v[28:31], v[100:103]
  ds_read_b64_tr_b16 v[48:49], v4 offset:4096
  ds_read_b64_tr_b16 v[50:51], v4 offset:6144
  v_mfma_f32_16x16x32_bf16 v[104:107], v[52:55], v[16:19], v[104:107]
  v_mfma_f32_16x16x32_bf16 v[108:111], v[52:55], v[20:23], v[108:111]
  ds_read_b128 v[36:39], v3 offset:2048
  v_mfma_f32_16x16x32_bf16 v[112:115], v[52:55], v[24:27], v[112:115]
  v_mfma_f32_16x16x32_bf16 v[116:119], v[52:55], v[28:31], v[116:119]
  ds_read_b64_tr_b16 v[52:53], v4 offset:12288
  ds_read_b64_tr_b16 v[54:55], v4 offset:14336
  v_mfma_f32_16x16x32_bf16 v[120:123], v[56:59], v[16:19], v[120:123]
  v_mfma_f32_16x16x32_bf16 v[124:127], v[56:59], v[20:23], v[124:127]
  ds_read_b128 v[40:43], v3 offset:4096
  v_mfma_f32_16x16x32_bf16 v[128:131], v[56:59], v[24:27], v[128:131]
  v_mfma_f32_16x16x32_bf16 v[132:135], v[56:59], v[28:31], v[132:135]
  ds_read_b64_tr_b16 v[56:57], v4 offset:20480
  ds_read_b64_tr_b16 v[58:59], v4 offset:22528
  s_waitcnt lgkmcnt(11)
  v_mfma_f32_16x16x32_bf16 v[136:139], v[60:63], v[16:19], v[136:139]
  v_mfma_f32_16x16x32_bf16 v[140:143], v[60:63], v[20:23], v[140:143]
  ds_read_b128 v[44:47], v3 offset:6144
  v_mfma_f32_16x16x32_bf16 v[144:147], v[60:63], v[24:27], v[144:147]
  v_mfma_f32_16x16x32_bf16 v[148:151], v[60:63], v[28:31], v[148:151]
  ds_read_b64_tr_b16 v[60:61], v4 offset:28672
  ds_read_b64_tr_b16 v[62:63], v4 offset:30720
  s_waitcnt lgkmcnt(12)
  v_mfma_f32_16x16x32_bf16 v[152:155], v[64:67], v[16:19], v[152:155]
  v_mfma_f32_16x16x32_bf16 v[156:159], v[64:67], v[20:23], v[156:159]
  v_mfma_f32_16x16x32_bf16 v[160:163], v[64:67], v[24:27], v[160:163]
  v_mfma_f32_16x16x32_bf16 v[164:167], v[64:67], v[28:31], v[164:167]
  ds_read_b64_tr_b16 v[64:65], v4 offset:36864
  ds_read_b64_tr_b16 v[66:67], v4 offset:38912
  s_add_u32 s44, s42, 40960
  s_cmp_eq_u32 s44, 122880
  s_cselect_b32 s44, 0, s44
  s_sub_u32 s45, s44, s42
  s_mov_b32 s42, s44
  s_waitcnt lgkmcnt(0)
  v_xor_b32 v2, 16384, v2
  v_xor_b32 v3, 16384, v3
  v_add_u32 v4, s45, v4
  s_barrier

  s_waitcnt lgkmcnt(4)
  v_mfma_f32_16x16x32_bf16 v[88:91], v[48:51], v[32:35], v[88:91]
  v_mfma_f32_16x16x32_bf16 v[92:95], v[48:51], v[36:39], v[92:95]
  ds_read_b128 v[16:19], v2 offset:0
  v_mfma_f32_16x16x32_bf16 v[96:99], v[48:51], v[40:43], v[96:99]
  v_mfma_f32_16x16x32_bf16 v[100:103], v[48:51], v[44:47], v[100:103]
  v_mfma_f32_16x16x32_bf16 v[68:71], v[48:51], v[8:11], v[68:71]
  ds_read_b64_tr_b16 v[48:49], v4 offset:0
  ds_read_b64_tr_b16 v[50:51], v4 offset:2048
  v_mfma_f32_16x16x32_bf16 v[104:107], v[52:55], v[32:35], v[104:107]
  v_mfma_f32_16x16x32_bf16 v[108:111], v[52:55], v[36:39], v[108:111]
  ds_read_b128 v[20:23], v2 offset:2048
  v_mfma_f32_16x16x32_bf16 v[112:115], v[52:55], v[40:43], v[112:115]
  v_mfma_f32_16x16x32_bf16 v[116:119], v[52:55], v[44:47], v[116:119]
  v_mfma_f32_16x16x32_bf16 v[72:75], v[52:55], v[8:11], v[72:75]
  ds_read_b64_tr_b16 v[52:53], v4 offset:8192
  ds_read_b64_tr_b16 v[54:55], v4 offset:10240
  v_mfma_f32_16x16x32_bf16 v[120:123], v[56:59], v[32:35], v[120:123]
  v_mfma_f32_16x16x32_bf16 v[124:127], v[56:59], v[36:39], v[124:127]
  ds_read_b128 v[24:27], v2 offset:4096
  v_mfma_f32_16x16x32_bf16 v[128:131], v[56:59], v[40:43], v[128:131]
  v_mfma_f32_16x16x32_bf16 v[132:135], v[56:59], v[44:47], v[132:135]
  v_mfma_f32_16x16x32_bf16 v[76:79], v[56:59], v[8:11], v[76:79]
  ds_read_b64_tr_b16 v[56:57], v4 offset:16384
  ds_read_b64_tr_b16 v[58:59], v4 offset:18432
  s_waitcnt lgkmcnt(11)
  v_mfma_f32_16x16x32_bf16 v[136:139], v[60:63], v[32:35], v[136:139]
  v_mfma_f32_16x16x32_bf16 v[140:143], v[60:63], v[36:39], v[140:143]
  ds_read_b128 v[28:31], v2 offset:6144
  v_mfma_f32_16x16x32_bf16 v[144:147], v[60:63], v[40:43], v[144:147]
  v_mfma_f32_16x16x32_bf16 v[148:151], v[60:63], v[44:47], v[148:151]
  v_mfma_f32_16x16x32_bf16 v[80:83], v[60:63], v[8:11], v[80:83]
  ds_read_b64_tr_b16 v[60:61], v4 offset:24576
  ds_read_b64_tr_b16 v[62:63], v4 offset:26624
  s_waitcnt lgkmcnt(12)
  v_mfma_f32_16x16x32_bf16 v[152:155], v[64:67], v[32:35], v[152:155]
  v_mfma_f32_16x16x32_bf16 v[156:159], v[64:67], v[36:39], v[156:159]
  v_mfma_f32_16x16x32_bf16 v[160:163], v[64:67], v[40:43], v[160:163]
  v_mfma_f32_16x16x32_bf16 v[164:167], v[64:67], v[44:47], v[164:167]
  v_mfma_f32_16x16x32_bf16 v[84:87], v[64:67], v[8:11], v[84:87]
  ds_read_b64_tr_b16 v[64:65], v4 offset:32768
  ds_read_b64_tr_b16 v[66:67], v4 offset:34816
  s_add_u32 s40, s40, 1
  s_cmp_lt_u32 s40, 8
  s_cbranch_scc1 gemm1_kernel_loopB1
  s_waitcnt lgkmcnt(0)
  s_branch gemm1_kernel_epiB

gemm1_kernel_epiB:
  s_nop 7
  s_nop 3
  s_and_b32 s16, s14, 1
  s_mul_i32 s16, s16, 1280
  s_lshr_b32 s15, s14, 1
  s_lshl_b32 s17, s15, 6
  s_add_u32 s16, s16, s17
  s_add_u32 s16, s16, 156672
  v_lshrrev_b32 v6, 4, v1
  v_lshl_add_u32 v16, v6, 4, s16

  ds_write_b128 v16, v[68:71] offset:0
  ds_write_b128 v16, v[72:75] offset:256
  ds_write_b128 v16, v[76:79] offset:512
  ds_write_b128 v16, v[80:83] offset:768
  ds_write_b128 v16, v[84:87] offset:1024
  s_waitcnt lgkmcnt(0)
  s_barrier
  s_and_b32 s30, s14, 1
  s_lshl_b32 s30, s30, 6
  s_lshl_b32 s31, s12, 7
  s_add_u32 s30, s30, s31
  v_and_b32 v5, 15, v1
  s_mov_b32 s40, 0xc0135761
  s_mov_b32 s41, 0xbdd2d3e8
  s_mov_b32 s42, 0x3eb8aa3b

  s_and_b32 s16, s14, 1
  s_lshl_b32 s16, s16, 8
  s_add_u32 s16, s16, 155648
  v_lshl_add_u32 v16, v5, 2, s16
  s_lshl_b32 s17, s15, 6
  s_add_u32 s17, s17, 156672
  v_lshl_add_u32 v17, v6, 4, s17

  ds_read_b32 v56, v16 offset:0
  ds_read_b32 v60, v16 offset:512
  ds_read_b32 v57, v16 offset:64
  ds_read_b32 v61, v16 offset:576
  ds_read_b32 v58, v16 offset:128
  ds_read_b32 v62, v16 offset:640
  ds_read_b32 v59, v16 offset:192
  ds_read_b32 v63, v16 offset:704
  ds_read_b128 v[64:67], v17 offset:0
  ds_read_b128 v[20:23], v17 offset:1280
  ds_read_b128 v[68:71], v17 offset:256
  ds_read_b128 v[24:27], v17 offset:1536
  ds_read_b128 v[72:75], v17 offset:512
  ds_read_b128 v[28:31], v17 offset:1792
  ds_read_b128 v[76:79], v17 offset:768
  ds_read_b128 v[32:35], v17 offset:2048
  ds_read_b128 v[80:83], v17 offset:1024
  ds_read_b128 v[36:39], v17 offset:2304
  s_waitcnt lgkmcnt(0)
  v_add_f32 v64, v64, v20
  v_add_f32 v65, v65, v21
  v_add_f32 v66, v66, v22
  v_add_f32 v67, v67, v23
  v_add_f32 v68, v68, v24
  v_add_f32 v69, v69, v25
  v_add_f32 v70, v70, v26
  v_add_f32 v71, v71, v27
  v_add_f32 v72, v72, v28
  v_add_f32 v73, v73, v29
  v_add_f32 v74, v74, v30
  v_add_f32 v75, v75, v31
  v_add_f32 v76, v76, v32
  v_add_f32 v77, v77, v33
  v_add_f32 v78, v78, v34
  v_add_f32 v79, v79, v35
  v_add_f32 v80, v80, v36
  v_add_f32 v81, v81, v37
  v_add_f32 v82, v82, v38
  v_add_f32 v83, v83, v39
  v_fma_f32 v88, v60, v64, v88
  v_fma_f32 v89, v60, v65, v89
  v_fma_f32 v90, v60, v66, v90
  v_fma_f32 v91, v60, v67, v91
  v_mul_f32 v88, v56, v88
  v_mul_f32 v89, v56, v89
  v_mul_f32 v90, v56, v90
  v_mul_f32 v91, v56, v91
  v_fma_f32 v92, v61, v64, v92
  v_fma_f32 v93, v61, v65, v93
  v_fma_f32 v94, v61, v66, v94
  v_fma_f32 v95, v61, v67, v95
  v_mul_f32 v92, v57, v92
  v_mul_f32 v93, v57, v93
  v_mul_f32 v94, v57, v94
  v_mul_f32 v95, v57, v95
  v_fma_f32 v96, v62, v64, v96
  v_fma_f32 v97, v62, v65, v97
  v_fma_f32 v98, v62, v66, v98
  v_fma_f32 v99, v62, v67, v99
  v_mul_f32 v96, v58, v96
  v_mul_f32 v97, v58, v97
  v_mul_f32 v98, v58, v98
  v_mul_f32 v99, v58, v99
  v_fma_f32 v100, v63, v64, v100
  v_fma_f32 v101, v63, v65, v101
  v_fma_f32 v102, v63, v66, v102
  v_fma_f32 v103, v63, v67, v103
  v_mul_f32 v100, v59, v100
  v_mul_f32 v101, v59, v101
  v_mul_f32 v102, v59, v102
  v_mul_f32 v103, v59, v103
  v_fma_f32 v104, v60, v68, v104
  v_fma_f32 v105, v60, v69, v105
  v_fma_f32 v106, v60, v70, v106
  v_fma_f32 v107, v60, v71, v107
  v_mul_f32 v104, v56, v104
  v_mul_f32 v105, v56, v105
  v_mul_f32 v106, v56, v106
  v_mul_f32 v107, v56, v107
  v_fma_f32 v108, v61, v68, v108
  v_fma_f32 v109, v61, v69, v109
  v_fma_f32 v110, v61, v70, v110
  v_fma_f32 v111, v61, v71, v111
  v_mul_f32 v108, v57, v108
  v_mul_f32 v109, v57, v109
  v_mul_f32 v110, v57, v110
  v_mul_f32 v111, v57, v111
  v_fma_f32 v112, v62, v68, v112
  v_fma_f32 v113, v62, v69, v113
  v_fma_f32 v114, v62, v70, v114
  v_fma_f32 v115, v62, v71, v115
  v_mul_f32 v112, v58, v112
  v_mul_f32 v113, v58, v113
  v_mul_f32 v114, v58, v114
  v_mul_f32 v115, v58, v115
  v_fma_f32 v116, v63, v68, v116
  v_fma_f32 v117, v63, v69, v117
  v_fma_f32 v118, v63, v70, v118
  v_fma_f32 v119, v63, v71, v119
  v_mul_f32 v116, v59, v116
  v_mul_f32 v117, v59, v117
  v_mul_f32 v118, v59, v118
  v_mul_f32 v119, v59, v119
  v_fma_f32 v120, v60, v72, v120
  v_fma_f32 v121, v60, v73, v121
  v_fma_f32 v122, v60, v74, v122
  v_fma_f32 v123, v60, v75, v123
  v_mul_f32 v120, v56, v120
  v_mul_f32 v121, v56, v121
  v_mul_f32 v122, v56, v122
  v_mul_f32 v123, v56, v123
  v_fma_f32 v124, v61, v72, v124
  v_fma_f32 v125, v61, v73, v125
  v_fma_f32 v126, v61, v74, v126
  v_fma_f32 v127, v61, v75, v127
  v_mul_f32 v124, v57, v124
  v_mul_f32 v125, v57, v125
  v_mul_f32 v126, v57, v126
  v_mul_f32 v127, v57, v127
  v_fma_f32 v128, v62, v72, v128
  v_fma_f32 v129, v62, v73, v129
  v_fma_f32 v130, v62, v74, v130
  v_fma_f32 v131, v62, v75, v131
  v_mul_f32 v128, v58, v128
  v_mul_f32 v129, v58, v129
  v_mul_f32 v130, v58, v130
  v_mul_f32 v131, v58, v131
  v_fma_f32 v132, v63, v72, v132
  v_fma_f32 v133, v63, v73, v133
  v_fma_f32 v134, v63, v74, v134
  v_fma_f32 v135, v63, v75, v135
  v_mul_f32 v132, v59, v132
  v_mul_f32 v133, v59, v133
  v_mul_f32 v134, v59, v134
  v_mul_f32 v135, v59, v135
  v_fma_f32 v136, v60, v76, v136
  v_fma_f32 v137, v60, v77, v137
  v_fma_f32 v138, v60, v78, v138
  v_fma_f32 v139, v60, v79, v139
  v_mul_f32 v136, v56, v136
  v_mul_f32 v137, v56, v137
  v_mul_f32 v138, v56, v138
  v_mul_f32 v139, v56, v139
  v_fma_f32 v140, v61, v76, v140
  v_fma_f32 v141, v61, v77, v141
  v_fma_f32 v142, v61, v78, v142
  v_fma_f32 v143, v61, v79, v143
  v_mul_f32 v140, v57, v140
  v_mul_f32 v141, v57, v141
  v_mul_f32 v142, v57, v142
  v_mul_f32 v143, v57, v143
  v_fma_f32 v144, v62, v76, v144
  v_fma_f32 v145, v62, v77, v145
  v_fma_f32 v146, v62, v78, v146
  v_fma_f32 v147, v62, v79, v147
  v_mul_f32 v144, v58, v144
  v_mul_f32 v145, v58, v145
  v_mul_f32 v146, v58, v146
  v_mul_f32 v147, v58, v147
  v_fma_f32 v148, v63, v76, v148
  v_fma_f32 v149, v63, v77, v149
  v_fma_f32 v150, v63, v78, v150
  v_fma_f32 v151, v63, v79, v151
  v_mul_f32 v148, v59, v148
  v_mul_f32 v149, v59, v149
  v_mul_f32 v150, v59, v150
  v_mul_f32 v151, v59, v151
  v_fma_f32 v152, v60, v80, v152
  v_fma_f32 v153, v60, v81, v153
  v_fma_f32 v154, v60, v82, v154
  v_fma_f32 v155, v60, v83, v155
  v_mul_f32 v152, v56, v152
  v_mul_f32 v153, v56, v153
  v_mul_f32 v154, v56, v154
  v_mul_f32 v155, v56, v155
  v_fma_f32 v156, v61, v80, v156
  v_fma_f32 v157, v61, v81, v157
  v_fma_f32 v158, v61, v82, v158
  v_fma_f32 v159, v61, v83, v159
  v_mul_f32 v156, v57, v156
  v_mul_f32 v157, v57, v157
  v_mul_f32 v158, v57, v158
  v_mul_f32 v159, v57, v159
  v_fma_f32 v160, v62, v80, v160
  v_fma_f32 v161, v62, v81, v161
  v_fma_f32 v162, v62, v82, v162
  v_fma_f32 v163, v62, v83, v163
  v_mul_f32 v160, v58, v160
  v_mul_f32 v161, v58, v161
  v_mul_f32 v162, v58, v162
  v_mul_f32 v163, v58, v163
  v_fma_f32 v164, v63, v80, v164
  v_fma_f32 v165, v63, v81, v165
  v_fma_f32 v166, v63, v82, v166
  v_fma_f32 v167, v63, v83, v167
  v_mul_f32 v164, v59, v164
  v_mul_f32 v165, v59, v165
  v_mul_f32 v166, v59, v166
  v_mul_f32 v167, v59, v167
  v_lshlrev_b32 v13, 4, v5
  v_lshrrev_b32 v7, 1, v6
  v_lshl_add_u32 v13, v7, 9, v13
  v_and_b32 v12, 1, v6
  v_lshl_add_u32 v13, v12, 3, v13
  v_lshlrev_b32 v14, 4, v5
  v_lshl_add_u32 v14, v12, 8, v14
  v_lshl_add_u32 v14, v7, 3, v14
  s_lshl_b32 s34, s30, 5

  s_sub_u32 s35, s13, 8
  s_lshl_b32 s35, s35, 2
  s_add_u32 s35, s35, s15
  s_lshl_b32 s35, s35, 16
  s_add_u32 s35, s35, s34
  s_add_u32 s35, s35, 4194304
  s_add_u32 s36, s4, s35
  s_addc_u32 s37, s5, 0

  v_cvt_pk_bf16_f32 v40, v88, v89
  v_cvt_pk_bf16_f32 v41, v90, v91
  global_store_dwordx2 v13, v[40:41], s[36:37] offset:0
  v_cvt_pk_bf16_f32 v42, v92, v93
  v_cvt_pk_bf16_f32 v43, v94, v95
  global_store_dwordx2 v13, v[42:43], s[36:37] offset:256
  v_cvt_pk_bf16_f32 v44, v96, v97
  v_cvt_pk_bf16_f32 v45, v98, v99
  global_store_dwordx2 v13, v[44:45], s[36:37] offset:1024
  v_cvt_pk_bf16_f32 v46, v100, v101
  v_cvt_pk_bf16_f32 v47, v102, v103
  global_store_dwordx2 v13, v[46:47], s[36:37] offset:1280
  s_sub_u32 s35, s13, 14
  s_lshl_b32 s35, s35, 4
  s_add_u32 s35, s35, s15
  s_add_u32 s35, s35, 0
  s_lshl_b32 s35, s35, 16
  s_add_u32 s35, s35, s34
  s_add_u32 s35, s35, 2097152
  s_add_u32 s36, s4, s35
  s_addc_u32 s37, s5, 0

  v_mul_f32 v104, s42, v104
  v_mul_f32 v105, s42, v105
  v_mul_f32 v106, s42, v106
  v_mul_f32 v107, s42, v107
  v_cvt_pk_bf16_f32 v48, v104, v105
  v_cvt_pk_bf16_f32 v49, v106, v107
  global_store_dwordx2 v13, v[48:49], s[36:37] offset:0
  v_mul_f32 v108, s42, v108
  v_mul_f32 v109, s42, v109
  v_mul_f32 v110, s42, v110
  v_mul_f32 v111, s42, v111
  v_cvt_pk_bf16_f32 v50, v108, v109
  v_cvt_pk_bf16_f32 v51, v110, v111
  global_store_dwordx2 v13, v[50:51], s[36:37] offset:256
  v_mul_f32 v112, s42, v112
  v_mul_f32 v113, s42, v113
  v_mul_f32 v114, s42, v114
  v_mul_f32 v115, s42, v115
  v_cvt_pk_bf16_f32 v52, v112, v113
  v_cvt_pk_bf16_f32 v53, v114, v115
  global_store_dwordx2 v13, v[52:53], s[36:37] offset:1024
  v_mul_f32 v116, s42, v116
  v_mul_f32 v117, s42, v117
  v_mul_f32 v118, s42, v118
  v_mul_f32 v119, s42, v119
  v_cvt_pk_bf16_f32 v54, v116, v117
  v_cvt_pk_bf16_f32 v55, v118, v119
  global_store_dwordx2 v13, v[54:55], s[36:37] offset:1280
  s_sub_u32 s35, s13, 14
  s_lshl_b32 s35, s35, 4
  s_add_u32 s35, s35, s15
  s_add_u32 s35, s35, 4
  s_lshl_b32 s35, s35, 16
  s_add_u32 s35, s35, s34
  s_add_u32 s35, s35, 2097152
  s_add_u32 s36, s4, s35
  s_addc_u32 s37, s5, 0

  v_mul_f32 v120, s42, v120
  v_mul_f32 v121, s42, v121
  v_mul_f32 v122, s42, v122
  v_mul_f32 v123, s42, v123
  v_cvt_pk_bf16_f32 v40, v120, v121
  v_cvt_pk_bf16_f32 v41, v122, v123
  global_store_dwordx2 v13, v[40:41], s[36:37] offset:0
  v_mul_f32 v124, s42, v124
  v_mul_f32 v125, s42, v125
  v_mul_f32 v126, s42, v126
  v_mul_f32 v127, s42, v127
  v_cvt_pk_bf16_f32 v42, v124, v125
  v_cvt_pk_bf16_f32 v43, v126, v127
  global_store_dwordx2 v13, v[42:43], s[36:37] offset:256
  v_mul_f32 v128, s42, v128
  v_mul_f32 v129, s42, v129
  v_mul_f32 v130, s42, v130
  v_mul_f32 v131, s42, v131
  v_cvt_pk_bf16_f32 v44, v128, v129
  v_cvt_pk_bf16_f32 v45, v130, v131
  global_store_dwordx2 v13, v[44:45], s[36:37] offset:1024
  v_mul_f32 v132, s42, v132
  v_mul_f32 v133, s42, v133
  v_mul_f32 v134, s42, v134
  v_mul_f32 v135, s42, v135
  v_cvt_pk_bf16_f32 v46, v132, v133
  v_cvt_pk_bf16_f32 v47, v134, v135
  global_store_dwordx2 v13, v[46:47], s[36:37] offset:1280
  s_sub_u32 s35, s13, 14
  s_lshl_b32 s35, s35, 4
  s_add_u32 s35, s35, s15
  s_add_u32 s35, s35, 8
  s_lshl_b32 s35, s35, 16
  s_add_u32 s35, s35, s34
  s_add_u32 s35, s35, 2097152
  s_add_u32 s36, s4, s35
  s_addc_u32 s37, s5, 0

  v_mul_f32 v136, s42, v136
  v_mul_f32 v137, s42, v137
  v_mul_f32 v138, s42, v138
  v_mul_f32 v139, s42, v139
  v_cvt_pk_bf16_f32 v48, v136, v137
  v_cvt_pk_bf16_f32 v49, v138, v139
  global_store_dwordx2 v13, v[48:49], s[36:37] offset:0
  v_mul_f32 v140, s42, v140
  v_mul_f32 v141, s42, v141
  v_mul_f32 v142, s42, v142
  v_mul_f32 v143, s42, v143
  v_cvt_pk_bf16_f32 v50, v140, v141
  v_cvt_pk_bf16_f32 v51, v142, v143
  global_store_dwordx2 v13, v[50:51], s[36:37] offset:256
  v_mul_f32 v144, s42, v144
  v_mul_f32 v145, s42, v145
  v_mul_f32 v146, s42, v146
  v_mul_f32 v147, s42, v147
  v_cvt_pk_bf16_f32 v52, v144, v145
  v_cvt_pk_bf16_f32 v53, v146, v147
  global_store_dwordx2 v13, v[52:53], s[36:37] offset:1024
  v_mul_f32 v148, s42, v148
  v_mul_f32 v149, s42, v149
  v_mul_f32 v150, s42, v150
  v_mul_f32 v151, s42, v151
  v_cvt_pk_bf16_f32 v54, v148, v149
  v_cvt_pk_bf16_f32 v55, v150, v151
  global_store_dwordx2 v13, v[54:55], s[36:37] offset:1280
  s_sub_u32 s35, s13, 14
  s_lshl_b32 s35, s35, 4
  s_add_u32 s35, s35, s15
  s_add_u32 s35, s35, 12
  s_lshl_b32 s35, s35, 16
  s_add_u32 s35, s35, s34
  s_add_u32 s35, s35, 2097152
  s_add_u32 s36, s4, s35
  s_addc_u32 s37, s5, 0

  v_mul_f32 v152, s42, v152
  v_mul_f32 v153, s42, v153
  v_mul_f32 v154, s42, v154
  v_mul_f32 v155, s42, v155
  v_cvt_pk_bf16_f32 v40, v152, v153
  v_cvt_pk_bf16_f32 v41, v154, v155
  global_store_dwordx2 v13, v[40:41], s[36:37] offset:0
  v_mul_f32 v156, s42, v156
  v_mul_f32 v157, s42, v157
  v_mul_f32 v158, s42, v158
  v_mul_f32 v159, s42, v159
  v_cvt_pk_bf16_f32 v42, v156, v157
  v_cvt_pk_bf16_f32 v43, v158, v159
  global_store_dwordx2 v13, v[42:43], s[36:37] offset:256
  v_mul_f32 v160, s42, v160
  v_mul_f32 v161, s42, v161
  v_mul_f32 v162, s42, v162
  v_mul_f32 v163, s42, v163
  v_cvt_pk_bf16_f32 v44, v160, v161
  v_cvt_pk_bf16_f32 v45, v162, v163
  global_store_dwordx2 v13, v[44:45], s[36:37] offset:1024
  v_mul_f32 v164, s42, v164
  v_mul_f32 v165, s42, v165
  v_mul_f32 v166, s42, v166
  v_mul_f32 v167, s42, v167
  v_cvt_pk_bf16_f32 v46, v164, v165
  v_cvt_pk_bf16_f32 v47, v166, v167
  global_store_dwordx2 v13, v[46:47], s[36:37] offset:1280
  s_endpgm
gemm1_kernel_loader:
  s_sub_u32 s14, s14, 8
  s_and_b32 s16, s14, 1
  s_lshl_b32 s16, s16, 2
  v_lshrrev_b32 v5, 4, v1
  v_add_u32 v5, s16, v5
  v_and_b32 v6, 7, v1
  v_xor_b32 v5, v5, v6
  v_lshlrev_b32 v5, 4, v5
  v_lshrrev_b32 v6, 3, v1
  v_lshl_add_u32 v16, v6, 10, v5
  v_add_u32 v17, 0x8000, v16
  v_add_u32 v18, 0x10000, v16
  v_add_u32 v19, 0x18000, v16
  v_lshrrev_b32 v5, 3, v1
  v_and_b32 v5, 3, v5
  v_lshrrev_b32 v6, 5, v1
  v_lshl_add_u32 v5, v6, 3, v5
  v_lshrrev_b32 v6, 1, v1
  v_lshrrev_b32 v7, 4, v1
  v_xor_b32 v6, v6, v7
  v_and_b32 v6, 3, v6
  v_lshlrev_b32 v6, 5, v6
  v_and_b32 v7, 1, v1
  v_lshl_add_u32 v6, v7, 4, v6
  v_mul_u32_u24 v7, 3072, v5
  v_add_u32 v20, v7, v6
  v_add_u32 v21, 98304, v20
  v_mul_u32_u24 v7, 3584, v5
  v_add_u32 v22, v7, v6
  v_add_u32 v23, 114688, v22
  s_waitcnt lgkmcnt(0)
  s_lshl_b32 s16, s12, 17
  s_lshl_b32 s17, s14, 13
  s_add_u32 s16, s16, s17
  s_add_u32 s16, s50, s16
  s_addc_u32 s17, s51, 0
  s_lshl_b32 s30, s14, 10
  s_lshr_b32 s32, s14, 1
  s_lshl_b32 s31, s32, 2
  s_and_b32 s32, s14, 1
  s_lshl_b32 s32, s32, 4
  s_add_u32 s31, s31, s32
  s_mul_i32 s32, s31, 3072
  s_mul_i32 s33, s31, 3584
  s_mov_b32 s46, 229376
  s_cmp_ge_u32 s13, 14
  s_cbranch_scc1 gemm1_kernel_srcB
  s_lshl_b32 s34, s13, 8
  s_add_u32 s34, s34, s33
  s_add_u32 s18, s8, s34
  s_addc_u32 s19, s9, 0
  s_add_u32 s20, s18, 128
  s_addc_u32 s21, s19, 0
  s_add_u32 s22, s10, s34
  s_addc_u32 s23, s11, 0
  s_add_u32 s24, s22, 128
  s_addc_u32 s25, s23, 0
  s_lshl_b32 s34, s13, 7
  s_add_u32 s35, s34, 2048
  s_cmp_lt_u32 s13, 8
  s_cselect_b32 s34, s35, s34
  s_add_u32 s34, s34, s32
  s_add_u32 s26, s6, s34
  s_addc_u32 s27, s7, 0
  s_branch gemm1_kernel_srcdone
  gemm1_kernel_srcB:
  s_lshl_b32 s34, s13, 7
  s_add_u32 s34, s34, s32
  s_add_u32 s18, s6, s34
  s_addc_u32 s19, s7, 0
  s_sub_u32 s34, s13, 14
  s_lshl_b32 s34, s34, 9
  s_add_u32 s34, s34, s32
  s_add_u32 s20, s6, s34
  s_addc_u32 s21, s7, 0
  s_add_u32 s22, s20, 128
  s_addc_u32 s23, s21, 0
  s_add_u32 s24, s20, 256
  s_addc_u32 s25, s21, 0
  s_add_u32 s26, s20, 384
  s_addc_u32 s27, s21, 0
  s_mov_b32 s46, 196608
  v_mov_b32 v22, v20
  v_mov_b32 v23, v21
  gemm1_kernel_srcdone:

  s_add_u32 s47, s30, 16384
  s_add_u32 s48, s30, 40960
  s_add_u32 s49, s30, 81920
  v_lshrrev_b32 v24, 2, v1
  v_and_b32 v25, 3, v1
  v_lshlrev_b32 v25, 4, v25
  v_lshl_add_u32 v24, v24, 10, v25
  s_lshl_b32 s52, s12, 17
  s_lshl_b32 s53, s14, 15
  s_add_u32 s52, s52, s53
  s_add_u32 s52, s50, s52
  s_addc_u32 s53, s51, 0
  s_add_u32 s54, s52, 16384
  s_addc_u32 s55, s53, 0
  s_load_dwordx2 s[56:57], s[0:1], 48
  s_load_dwordx2 s[58:59], s[0:1], 16

  s_add_u32 m0, s30, 0
  s_nop 0
  global_load_lds_dwordx4 v16, s[16:17]
  s_add_u32 m0, s30, 4096
  s_nop 0
  global_load_lds_dwordx4 v17, s[16:17]
  s_add_u32 m0, s30, 8192
  s_nop 0
  global_load_lds_dwordx4 v18, s[16:17]
  s_add_u32 m0, s30, 12288
  s_nop 0
  global_load_lds_dwordx4 v19, s[16:17]
  s_add_u32 s16, s16, 128
  s_addc_u32 s17, s17, 0
  s_add_u32 m0, s30, 32768
  s_nop 0
  global_load_lds_dwordx4 v22, s[18:19]
  s_add_u32 m0, s30, 36864
  s_nop 0
  global_load_lds_dwordx4 v23, s[18:19]
  s_add_u32 s18, s18, s46
  s_addc_u32 s19, s19, 0
  s_add_u32 m0, s30, 40960
  s_nop 0
  global_load_lds_dwordx4 v22, s[20:21]
  s_add_u32 m0, s30, 45056
  s_nop 0
  global_load_lds_dwordx4 v23, s[20:21]
  s_add_u32 s20, s20, s46
  s_addc_u32 s21, s21, 0
  s_add_u32 m0, s30, 49152
  s_nop 0
  global_load_lds_dwordx4 v22, s[22:23]
  s_add_u32 m0, s30, 53248
  s_nop 0
  global_load_lds_dwordx4 v23, s[22:23]
  s_add_u32 s22, s22, s46
  s_addc_u32 s23, s23, 0
  s_add_u32 m0, s30, 57344
  s_nop 0
  global_load_lds_dwordx4 v22, s[24:25]
  s_add_u32 m0, s30, 61440
  s_nop 0
  global_load_lds_dwordx4 v23, s[24:25]
  s_add_u32 s24, s24, s46
  s_addc_u32 s25, s25, 0
  s_add_u32 m0, s30, 65536
  s_nop 0
  global_load_lds_dwordx4 v20, s[26:27]
  s_add_u32 m0, s30, 69632
  s_nop 0
  global_load_lds_dwordx4 v21, s[26:27]
  s_add_u32 s26, s26, 196608
  s_addc_u32 s27, s27, 0
  s_add_u32 m0, s47, 0
  s_nop 0
  global_load_lds_dwordx4 v16, s[16:17]
  s_add_u32 m0, s47, 4096
  s_nop 0
  global_load_lds_dwordx4 v17, s[16:17]
  s_add_u32 m0, s47, 8192
  s_nop 0
  global_load_lds_dwordx4 v18, s[16:17]
  s_add_u32 m0, s47, 12288
  s_nop 0
  global_load_lds_dwordx4 v19, s[16:17]
  s_add_u32 s16, s16, 128
  s_addc_u32 s17, s17, 0
  s_add_u32 m0, s48, 32768
  s_nop 0
  global_load_lds_dwordx4 v22, s[18:19]
  s_add_u32 m0, s48, 36864
  s_nop 0
  global_load_lds_dwordx4 v23, s[18:19]
  s_add_u32 s18, s18, s46
  s_addc_u32 s19, s19, 0
  s_add_u32 m0, s48, 40960
  s_nop 0
  global_load_lds_dwordx4 v22, s[20:21]
  s_add_u32 m0, s48, 45056
  s_nop 0
  global_load_lds_dwordx4 v23, s[20:21]
  s_add_u32 s20, s20, s46
  s_addc_u32 s21, s21, 0
  s_add_u32 m0, s48, 49152
  s_nop 0
  global_load_lds_dwordx4 v22, s[22:23]
  s_add_u32 m0, s48, 53248
  s_nop 0
  global_load_lds_dwordx4 v23, s[22:23]
  s_add_u32 s22, s22, s46
  s_addc_u32 s23, s23, 0
  s_add_u32 m0, s48, 57344
  s_nop 0
  global_load_lds_dwordx4 v22, s[24:25]
  s_add_u32 m0, s48, 61440
  s_nop 0
  global_load_lds_dwordx4 v23, s[24:25]
  s_add_u32 s24, s24, s46
  s_addc_u32 s25, s25, 0
  s_add_u32 m0, s48, 65536
  s_nop 0
  global_load_lds_dwordx4 v20, s[26:27]
  s_add_u32 m0, s48, 69632
  s_nop 0
  global_load_lds_dwordx4 v21, s[26:27]
  s_add_u32 s26, s26, 196608
  s_addc_u32 s27, s27, 0
  s_add_u32 m0, s49, 32768
  s_nop 0
  global_load_lds_dwordx4 v22, s[18:19]
  s_add_u32 m0, s49, 36864
  s_nop 0
  global_load_lds_dwordx4 v23, s[18:19]
  s_add_u32 s18, s18, s46
  s_addc_u32 s19, s19, 0
  s_add_u32 m0, s49, 40960
  s_nop 0
  global_load_lds_dwordx4 v22, s[20:21]
  s_add_u32 m0, s49, 45056
  s_nop 0
  global_load_lds_dwordx4 v23, s[20:21]
  s_add_u32 s20, s20, s46
  s_addc_u32 s21, s21, 0
  s_add_u32 m0, s49, 49152
  s_nop 0
  global_load_lds_dwordx4 v22, s[22:23]
  s_add_u32 m0, s49, 53248
  s_nop 0
  global_load_lds_dwordx4 v23, s[22:23]
  s_add_u32 s22, s22, s46
  s_addc_u32 s23, s23, 0
  s_add_u32 m0, s49, 57344
  s_nop 0
  global_load_lds_dwordx4 v22, s[24:25]
  s_add_u32 m0, s49, 61440
  s_nop 0
  global_load_lds_dwordx4 v23, s[24:25]
  s_add_u32 s24, s24, s46
  s_addc_u32 s25, s25, 0
  s_add_u32 m0, s49, 65536
  s_nop 0
  global_load_lds_dwordx4 v20, s[26:27]
  s_add_u32 m0, s49, 69632
  s_nop 0
  global_load_lds_dwordx4 v21, s[26:27]
  s_add_u32 s26, s26, 196608
  s_addc_u32 s27, s27, 0
  v_and_b32 v26, 31, v1
  v_lshrrev_b32 v27, 5, v1
  v_lshlrev_b32 v26, 1, v26
  v_lshl_add_u32 v26, v27, 13, v26
  v_add_u32 v27, 4096, v26
  v_lshlrev_b32 v28, 4, v1
  s_lshl_b32 s72, s2, 2
  s_add_u32 s72, s72, s14
  s_waitcnt lgkmcnt(0)
  s_mov_b64 s[74:75], s[4:5]
  s_mov_b64 s[76:77], s[4:5]
  s_mov_b64 s[78:79], s[4:5]
  s_mov_b64 s[80:81], s[56:57]
  s_waitcnt vmcnt(24)
  s_barrier

  v_and_b32 v2, 15, v1
  v_lshrrev_b32 v3, 1, v2
  v_lshrrev_b32 v4, 4, v1
  v_xor_b32 v3, v3, v4
  v_lshlrev_b32 v3, 4, v3
  v_lshl_add_u32 v2, v2, 7, v3
  s_lshl_b32 s82, s14, 12
  v_add_u32 v60, s82, v2
  v_xor_b32 v61, 64, v60

  v_mov_b32 v96, 0x3f803f80
  v_mov_b32 v97, 0x3f803f80
  v_mov_b32 v98, 0x3f803f80
  v_mov_b32 v99, 0x3f803f80
  v_mov_b32 v80, 0
  v_mov_b32 v81, 0
  v_mov_b32 v82, 0
  v_mov_b32 v83, 0
  v_mov_b32 v84, 0
  v_mov_b32 v85, 0
  v_mov_b32 v86, 0
  v_mov_b32 v87, 0
  v_mov_b32 v88, 0
  v_mov_b32 v89, 0
  v_mov_b32 v90, 0
  v_mov_b32 v91, 0
  v_mov_b32 v92, 0
  v_mov_b32 v93, 0
  v_mov_b32 v94, 0
  v_mov_b32 v95, 0
  ds_read_b128 v[64:67], v60 offset:0
  ds_read_b128 v[68:71], v61 offset:0
  ds_read_b128 v[72:75], v60 offset:2048
  ds_read_b128 v[76:79], v61 offset:2048
  s_waitcnt lgkmcnt(0)
  v_mfma_f32_16x16x32_bf16 v[80:83], v[64:67], v[96:99], v[80:83]
  v_mfma_f32_16x16x32_bf16 v[88:91], v[64:67], v[64:67], v[88:91]
  v_mfma_f32_16x16x32_bf16 v[84:87], v[72:75], v[96:99], v[84:87]
  v_mfma_f32_16x16x32_bf16 v[92:95], v[72:75], v[72:75], v[92:95]
  v_mfma_f32_16x16x32_bf16 v[80:83], v[68:71], v[96:99], v[80:83]
  v_mfma_f32_16x16x32_bf16 v[88:91], v[68:71], v[68:71], v[88:91]
  v_mfma_f32_16x16x32_bf16 v[84:87], v[76:79], v[96:99], v[84:87]
  v_mfma_f32_16x16x32_bf16 v[92:95], v[76:79], v[76:79], v[92:95]
  s_waitcnt vmcnt(10)
  s_barrier
  s_add_u32 s45, s30, 0
  s_add_u32 m0, s45, 0
  s_nop 0
  global_load_lds_dwordx4 v16, s[16:17]
  s_add_u32 m0, s45, 4096
  s_nop 0
  global_load_lds_dwordx4 v17, s[16:17]
  s_add_u32 m0, s45, 8192
  s_nop 0
  global_load_lds_dwordx4 v18, s[16:17]
  s_add_u32 m0, s45, 12288
  s_nop 0
  global_load_lds_dwordx4 v19, s[16:17]
  s_add_u32 s16, s16, 128
  s_addc_u32 s17, s17, 0
  s_add_u32 s45, s30, 0
  s_add_u32 m0, s45, 32768
  s_nop 0
  global_load_lds_dwordx4 v22, s[18:19]
  s_add_u32 m0, s45, 36864
  s_nop 0
  global_load_lds_dwordx4 v23, s[18:19]
  s_add_u32 s18, s18, s46
  s_addc_u32 s19, s19, 0
  s_add_u32 m0, s45, 40960
  s_nop 0
  global_load_lds_dwordx4 v22, s[20:21]
  s_add_u32 m0, s45, 45056
  s_nop 0
  global_load_lds_dwordx4 v23, s[20:21]
  s_add_u32 s20, s20, s46
  s_addc_u32 s21, s21, 0
  s_add_u32 m0, s45, 49152
  s_nop 0
  global_load_lds_dwordx4 v22, s[22:23]
  s_add_u32 m0, s45, 53248
  s_nop 0
  global_load_lds_dwordx4 v23, s[22:23]
  s_add_u32 s22, s22, s46
  s_addc_u32 s23, s23, 0
  s_add_u32 m0, s45, 57344
  s_nop 0
  global_load_lds_dwordx4 v22, s[24:25]
  s_add_u32 m0, s45, 61440
  s_nop 0
  global_load_lds_dwordx4 v23, s[24:25]
  s_add_u32 s24, s24, s46
  s_addc_u32 s25, s25, 0
  s_add_u32 m0, s45, 65536
  s_nop 0
  global_load_lds_dwordx4 v20, s[26:27]
  s_add_u32 m0, s45, 69632
  s_nop 0
  global_load_lds_dwordx4 v21, s[26:27]
  s_add_u32 s26, s26, 196608
  s_addc_u32 s27, s27, 0
  ds_read_b128 v[64:67], v60 offset:16384
  ds_read_b128 v[68:71], v61 offset:16384
  ds_read_b128 v[72:75], v60 offset:18432
  ds_read_b128 v[76:79], v61 offset:18432
  s_waitcnt lgkmcnt(0)
  v_mfma_f32_16x16x32_bf16 v[80:83], v[64:67], v[96:99], v[80:83]
  v_mfma_f32_16x16x32_bf16 v[88:91], v[64:67], v[64:67], v[88:91]
  v_mfma_f32_16x16x32_bf16 v[84:87], v[72:75], v[96:99], v[84:87]
  v_mfma_f32_16x16x32_bf16 v[92:95], v[72:75], v[72:75], v[92:95]
  v_mfma_f32_16x16x32_bf16 v[80:83], v[68:71], v[96:99], v[80:83]
  v_mfma_f32_16x16x32_bf16 v[88:91], v[68:71], v[68:71], v[88:91]
  v_mfma_f32_16x16x32_bf16 v[84:87], v[76:79], v[96:99], v[84:87]
  v_mfma_f32_16x16x32_bf16 v[92:95], v[76:79], v[76:79], v[92:95]
  s_waitcnt vmcnt(10)
  s_barrier
  s_add_u32 s45, s30, 16384
  s_add_u32 m0, s45, 0
  s_nop 0
  global_load_lds_dwordx4 v16, s[16:17]
  s_add_u32 m0, s45, 4096
  s_nop 0
  global_load_lds_dwordx4 v17, s[16:17]
  s_add_u32 m0, s45, 8192
  s_nop 0
  global_load_lds_dwordx4 v18, s[16:17]
  s_add_u32 m0, s45, 12288
  s_nop 0
  global_load_lds_dwordx4 v19, s[16:17]
  s_add_u32 s16, s16, 128
  s_addc_u32 s17, s17, 0
  s_add_u32 s45, s30, 40960
  s_add_u32 m0, s45, 32768
  s_nop 0
  global_load_lds_dwordx4 v22, s[18:19]
  s_add_u32 m0, s45, 36864
  s_nop 0
  global_load_lds_dwordx4 v23, s[18:19]
  s_add_u32 s18, s18, s46
  s_addc_u32 s19, s19, 0
  s_add_u32 m0, s45, 40960
  s_nop 0
  global_load_lds_dwordx4 v22, s[20:21]
  s_add_u32 m0, s45, 45056
  s_nop 0
  global_load_lds_dwordx4 v23, s[20:21]
  s_add_u32 s20, s20, s46
  s_addc_u32 s21, s21, 0
  s_add_u32 m0, s45, 49152
  s_nop 0
  global_load_lds_dwordx4 v22, s[22:23]
  s_add_u32 m0, s45, 53248
  s_nop 0
  global_load_lds_dwordx4 v23, s[22:23]
  s_add_u32 s22, s22, s46
  s_addc_u32 s23, s23, 0
  s_add_u32 m0, s45, 57344
  s_nop 0
  global_load_lds_dwordx4 v22, s[24:25]
  s_add_u32 m0, s45, 61440
  s_nop 0
  global_load_lds_dwordx4 v23, s[24:25]
  s_add_u32 s24, s24, s46
  s_addc_u32 s25, s25, 0
  s_add_u32 m0, s45, 65536
  s_nop 0
  global_load_lds_dwordx4 v20, s[26:27]
  s_add_u32 m0, s45, 69632
  s_nop 0
  global_load_lds_dwordx4 v21, s[26:27]
  s_add_u32 s26, s26, 196608
  s_addc_u32 s27, s27, 0
  ds_read_b128 v[64:67], v60 offset:0
  ds_read_b128 v[68:71], v61 offset:0
  ds_read_b128 v[72:75], v60 offset:2048
  ds_read_b128 v[76:79], v61 offset:2048
  s_waitcnt lgkmcnt(0)
  v_mfma_f32_16x16x32_bf16 v[80:83], v[64:67], v[96:99], v[80:83]
  v_mfma_f32_16x16x32_bf16 v[88:91], v[64:67], v[64:67], v[88:91]
  v_mfma_f32_16x16x32_bf16 v[84:87], v[72:75], v[96:99], v[84:87]
  v_mfma_f32_16x16x32_bf16 v[92:95], v[72:75], v[72:75], v[92:95]
  v_mfma_f32_16x16x32_bf16 v[80:83], v[68:71], v[96:99], v[80:83]
  v_mfma_f32_16x16x32_bf16 v[88:91], v[68:71], v[68:71], v[88:91]
  v_mfma_f32_16x16x32_bf16 v[84:87], v[76:79], v[96:99], v[84:87]
  v_mfma_f32_16x16x32_bf16 v[92:95], v[76:79], v[76:79], v[92:95]
  s_add_u32 s82, s72, 0
  s_min_u32 s82, s82, 2303
  s_cmp_ge_u32 s82, 1792
  s_cbranch_scc1 gemm1_kernel_tr0_wo
  s_mul_hi_u32 s83, s82, 38347923
  s_mul_i32 s84, s83, 112
  s_sub_u32 s84, s82, s84
  s_lshl_b32 s85, s84, 14
  s_lshl_b32 s86, s83, 6
  s_add_u32 s85, s85, s86
  s_add_u32 s80, s56, s85
  s_addc_u32 s81, s57, 0
  s_lshl_b32 s85, s82, 10
  s_add_u32 s85, s85, 23068672
  s_branch gemm1_kernel_tr0_go
  gemm1_kernel_tr0_wo:
  s_sub_u32 s82, s82, 1792
  s_lshr_b32 s83, s82, 5
  s_and_b32 s84, s82, 31
  s_lshl_b32 s85, s84, 14
  s_lshl_b32 s86, s83, 6
  s_add_u32 s85, s85, s86
  s_add_u32 s80, s58, s85
  s_addc_u32 s81, s59, 0
  s_lshl_b32 s85, s82, 10
  s_add_u32 s85, s85, 25165824
  gemm1_kernel_tr0_go:
  s_add_u32 s74, s4, s85
  s_addc_u32 s75, s5, 0

  global_load_ushort v32, v26, s[80:81] offset:0
  global_load_ushort v33, v26, s[80:81] offset:1024
  global_load_ushort v34, v26, s[80:81] offset:2048
  global_load_ushort v35, v26, s[80:81] offset:3072
  global_load_ushort v36, v27, s[80:81] offset:0
  global_load_ushort v37, v27, s[80:81] offset:1024
  global_load_ushort v38, v27, s[80:81] offset:2048
  global_load_ushort v39, v27, s[80:81] offset:3072
  s_add_u32 s82, s72, 1024
  s_min_u32 s82, s82, 2303
  s_cmp_ge_u32 s82, 1792
  s_cbranch_scc1 gemm1_kernel_tr1_wo
  s_mul_hi_u32 s83, s82, 38347923
  s_mul_i32 s84, s83, 112
  s_sub_u32 s84, s82, s84
  s_lshl_b32 s85, s84, 14
  s_lshl_b32 s86, s83, 6
  s_add_u32 s85, s85, s86
  s_add_u32 s80, s56, s85
  s_addc_u32 s81, s57, 0
  s_lshl_b32 s85, s82, 10
  s_add_u32 s85, s85, 23068672
  s_branch gemm1_kernel_tr1_go
  gemm1_kernel_tr1_wo:
  s_sub_u32 s82, s82, 1792
  s_lshr_b32 s83, s82, 5
  s_and_b32 s84, s82, 31
  s_lshl_b32 s85, s84, 14
  s_lshl_b32 s86, s83, 6
  s_add_u32 s85, s85, s86
  s_add_u32 s80, s58, s85
  s_addc_u32 s81, s59, 0
  s_lshl_b32 s85, s82, 10
  s_add_u32 s85, s85, 25165824
  gemm1_kernel_tr1_go:
  s_add_u32 s76, s4, s85
  s_addc_u32 s77, s5, 0

  global_load_ushort v40, v26, s[80:81] offset:0
  global_load_ushort v41, v26, s[80:81] offset:1024
  global_load_ushort v42, v26, s[80:81] offset:2048
  global_load_ushort v43, v26, s[80:81] offset:3072
  global_load_ushort v44, v27, s[80:81] offset:0
  global_load_ushort v45, v27, s[80:81] offset:1024
  global_load_ushort v46, v27, s[80:81] offset:2048
  global_load_ushort v47, v27, s[80:81] offset:3072
  s_add_u32 s82, s72, 2048
  s_min_u32 s82, s82, 2303
  s_cmp_ge_u32 s82, 1792
  s_cbranch_scc1 gemm1_kernel_tr2_wo
  s_mul_hi_u32 s83, s82, 38347923
  s_mul_i32 s84, s83, 112
  s_sub_u32 s84, s82, s84
  s_lshl_b32 s85, s84, 14
  s_lshl_b32 s86, s83, 6
  s_add_u32 s85, s85, s86
  s_add_u32 s80, s56, s85
  s_addc_u32 s81, s57, 0
  s_lshl_b32 s85, s82, 10
  s_add_u32 s85, s85, 23068672
  s_branch gemm1_kernel_tr2_go
  gemm1_kernel_tr2_wo:
  s_sub_u32 s82, s82, 1792
  s_lshr_b32 s83, s82, 5
  s_and_b32 s84, s82, 31
  s_lshl_b32 s85, s84, 14
  s_lshl_b32 s86, s83, 6
  s_add_u32 s85, s85, s86
  s_add_u32 s80, s58, s85
  s_addc_u32 s81, s59, 0
  s_lshl_b32 s85, s82, 10
  s_add_u32 s85, s85, 25165824
  gemm1_kernel_tr2_go:
  s_add_u32 s78, s4, s85
  s_addc_u32 s79, s5, 0

  global_load_ushort v48, v26, s[80:81] offset:0
  global_load_ushort v49, v26, s[80:81] offset:1024
  global_load_ushort v50, v26, s[80:81] offset:2048
  global_load_ushort v51, v26, s[80:81] offset:3072
  global_load_ushort v52, v27, s[80:81] offset:0
  global_load_ushort v53, v27, s[80:81] offset:1024
  global_load_ushort v54, v27, s[80:81] offset:2048
  global_load_ushort v55, v27, s[80:81] offset:3072
  s_waitcnt vmcnt(34)
  s_barrier
  s_add_u32 s45, s30, 0
  s_add_u32 m0, s45, 0
  s_nop 0
  global_load_lds_dwordx4 v16, s[16:17]
  s_add_u32 m0, s45, 4096
  s_nop 0
  global_load_lds_dwordx4 v17, s[16:17]
  s_add_u32 m0, s45, 8192
  s_nop 0
  global_load_lds_dwordx4 v18, s[16:17]
  s_add_u32 m0, s45, 12288
  s_nop 0
  global_load_lds_dwordx4 v19, s[16:17]
  s_add_u32 s16, s16, 128
  s_addc_u32 s17, s17, 0
  s_add_u32 s45, s30, 81920
  s_add_u32 m0, s45, 32768
  s_nop 0
  global_load_lds_dwordx4 v22, s[18:19]
  s_add_u32 m0, s45, 36864
  s_nop 0
  global_load_lds_dwordx4 v23, s[18:19]
  s_add_u32 s18, s18, s46
  s_addc_u32 s19, s19, 0
  s_add_u32 m0, s45, 40960
  s_nop 0
  global_load_lds_dwordx4 v22, s[20:21]
  s_add_u32 m0, s45, 45056
  s_nop 0
  global_load_lds_dwordx4 v23, s[20:21]
  s_add_u32 s20, s20, s46
  s_addc_u32 s21, s21, 0
  s_add_u32 m0, s45, 49152
  s_nop 0
  global_load_lds_dwordx4 v22, s[22:23]
  s_add_u32 m0, s45, 53248
  s_nop 0
  global_load_lds_dwordx4 v23, s[22:23]
  s_add_u32 s22, s22, s46
  s_addc_u32 s23, s23, 0
  s_add_u32 m0, s45, 57344
  s_nop 0
  global_load_lds_dwordx4 v22, s[24:25]
  s_add_u32 m0, s45, 61440
  s_nop 0
  global_load_lds_dwordx4 v23, s[24:25]
  s_add_u32 s24, s24, s46
  s_addc_u32 s25, s25, 0
  s_add_u32 m0, s45, 65536
  s_nop 0
  global_load_lds_dwordx4 v20, s[26:27]
  s_add_u32 m0, s45, 69632
  s_nop 0
  global_load_lds_dwordx4 v21, s[26:27]
  s_add_u32 s26, s26, 196608
  s_addc_u32 s27, s27, 0
  ds_read_b128 v[64:67], v60 offset:16384
  ds_read_b128 v[68:71], v61 offset:16384
  ds_read_b128 v[72:75], v60 offset:18432
  ds_read_b128 v[76:79], v61 offset:18432
  s_waitcnt lgkmcnt(0)
  v_mfma_f32_16x16x32_bf16 v[80:83], v[64:67], v[96:99], v[80:83]
  v_mfma_f32_16x16x32_bf16 v[88:91], v[64:67], v[64:67], v[88:91]
  v_mfma_f32_16x16x32_bf16 v[84:87], v[72:75], v[96:99], v[84:87]
  v_mfma_f32_16x16x32_bf16 v[92:95], v[72:75], v[72:75], v[92:95]
  v_mfma_f32_16x16x32_bf16 v[80:83], v[68:71], v[96:99], v[80:83]
  v_mfma_f32_16x16x32_bf16 v[88:91], v[68:71], v[68:71], v[88:91]
  v_mfma_f32_16x16x32_bf16 v[84:87], v[76:79], v[96:99], v[84:87]
  v_mfma_f32_16x16x32_bf16 v[92:95], v[76:79], v[76:79], v[92:95]
  s_waitcnt vmcnt(10)
  s_barrier
  s_add_u32 s45, s30, 16384
  s_add_u32 m0, s45, 0
  s_nop 0
  global_load_lds_dwordx4 v16, s[16:17]
  s_add_u32 m0, s45, 4096
  s_nop 0
  global_load_lds_dwordx4 v17, s[16:17]
  s_add_u32 m0, s45, 8192
  s_nop 0
  global_load_lds_dwordx4 v18, s[16:17]
  s_add_u32 m0, s45, 12288
  s_nop 0
  global_load_lds_dwordx4 v19, s[16:17]
  s_add_u32 s16, s16, 128
  s_addc_u32 s17, s17, 0
  s_add_u32 s45, s30, 0
  s_add_u32 m0, s45, 32768
  s_nop 0
  global_load_lds_dwordx4 v22, s[18:19]
  s_add_u32 m0, s45, 36864
  s_nop 0
  global_load_lds_dwordx4 v23, s[18:19]
  s_add_u32 s18, s18, s46
  s_addc_u32 s19, s19, 0
  s_add_u32 m0, s45, 40960
  s_nop 0
  global_load_lds_dwordx4 v22, s[20:21]
  s_add_u32 m0, s45, 45056
  s_nop 0
  global_load_lds_dwordx4 v23, s[20:21]
  s_add_u32 s20, s20, s46
  s_addc_u32 s21, s21, 0
  s_add_u32 m0, s45, 49152
  s_nop 0
  global_load_lds_dwordx4 v22, s[22:23]
  s_add_u32 m0, s45, 53248
  s_nop 0
  global_load_lds_dwordx4 v23, s[22:23]
  s_add_u32 s22, s22, s46
  s_addc_u32 s23, s23, 0
  s_add_u32 m0, s45, 57344
  s_nop 0
  global_load_lds_dwordx4 v22, s[24:25]
  s_add_u32 m0, s45, 61440
  s_nop 0
  global_load_lds_dwordx4 v23, s[24:25]
  s_add_u32 s24, s24, s46
  s_addc_u32 s25, s25, 0
  s_add_u32 m0, s45, 65536
  s_nop 0
  global_load_lds_dwordx4 v20, s[26:27]
  s_add_u32 m0, s45, 69632
  s_nop 0
  global_load_lds_dwordx4 v21, s[26:27]
  s_add_u32 s26, s26, 196608
  s_addc_u32 s27, s27, 0
  ds_read_b128 v[64:67], v60 offset:0
  ds_read_b128 v[68:71], v61 offset:0
  ds_read_b128 v[72:75], v60 offset:2048
  ds_read_b128 v[76:79], v61 offset:2048
  s_waitcnt lgkmcnt(0)
  v_mfma_f32_16x16x32_bf16 v[80:83], v[64:67], v[96:99], v[80:83]
  v_mfma_f32_16x16x32_bf16 v[88:91], v[64:67], v[64:67], v[88:91]
  v_mfma_f32_16x16x32_bf16 v[84:87], v[72:75], v[96:99], v[84:87]
  v_mfma_f32_16x16x32_bf16 v[92:95], v[72:75], v[72:75], v[92:95]
  v_mfma_f32_16x16x32_bf16 v[80:83], v[68:71], v[96:99], v[80:83]
  v_mfma_f32_16x16x32_bf16 v[88:91], v[68:71], v[68:71], v[88:91]
  v_mfma_f32_16x16x32_bf16 v[84:87], v[76:79], v[96:99], v[84:87]
  v_mfma_f32_16x16x32_bf16 v[92:95], v[76:79], v[76:79], v[92:95]
  v_lshl_or_b32 v32, v33, 16, v32
  v_lshl_or_b32 v33, v35, 16, v34
  v_lshl_or_b32 v34, v37, 16, v36
  v_lshl_or_b32 v35, v39, 16, v38
  global_store_dwordx4 v28, v[32:35], s[74:75]

  v_lshl_or_b32 v40, v41, 16, v40
  v_lshl_or_b32 v41, v43, 16, v42
  v_lshl_or_b32 v42, v45, 16, v44
  v_lshl_or_b32 v43, v47, 16, v46
  global_store_dwordx4 v28, v[40:43], s[76:77]

  v_lshl_or_b32 v48, v49, 16, v48
  v_lshl_or_b32 v49, v51, 16, v50
  v_lshl_or_b32 v50, v53, 16, v52
  v_lshl_or_b32 v51, v55, 16, v54
  global_store_dwordx4 v28, v[48:51], s[78:79]

  s_waitcnt vmcnt(13)
  s_barrier
  s_add_u32 s45, s30, 0
  s_add_u32 m0, s45, 0
  s_nop 0
  global_load_lds_dwordx4 v16, s[16:17]
  s_add_u32 m0, s45, 4096
  s_nop 0
  global_load_lds_dwordx4 v17, s[16:17]
  s_add_u32 m0, s45, 8192
  s_nop 0
  global_load_lds_dwordx4 v18, s[16:17]
  s_add_u32 m0, s45, 12288
  s_nop 0
  global_load_lds_dwordx4 v19, s[16:17]
  s_add_u32 s16, s16, 128
  s_addc_u32 s17, s17, 0
  s_add_u32 s45, s30, 40960
  s_add_u32 m0, s45, 32768
  s_nop 0
  global_load_lds_dwordx4 v22, s[18:19]
  s_add_u32 m0, s45, 36864
  s_nop 0
  global_load_lds_dwordx4 v23, s[18:19]
  s_add_u32 s18, s18, s46
  s_addc_u32 s19, s19, 0
  s_add_u32 m0, s45, 40960
  s_nop 0
  global_load_lds_dwordx4 v22, s[20:21]
  s_add_u32 m0, s45, 45056
  s_nop 0
  global_load_lds_dwordx4 v23, s[20:21]
  s_add_u32 s20, s20, s46
  s_addc_u32 s21, s21, 0
  s_add_u32 m0, s45, 49152
  s_nop 0
  global_load_lds_dwordx4 v22, s[22:23]
  s_add_u32 m0, s45, 53248
  s_nop 0
  global_load_lds_dwordx4 v23, s[22:23]
  s_add_u32 s22, s22, s46
  s_addc_u32 s23, s23, 0
  s_add_u32 m0, s45, 57344
  s_nop 0
  global_load_lds_dwordx4 v22, s[24:25]
  s_add_u32 m0, s45, 61440
  s_nop 0
  global_load_lds_dwordx4 v23, s[24:25]
  s_add_u32 s24, s24, s46
  s_addc_u32 s25, s25, 0
  s_add_u32 m0, s45, 65536
  s_nop 0
  global_load_lds_dwordx4 v20, s[26:27]
  s_add_u32 m0, s45, 69632
  s_nop 0
  global_load_lds_dwordx4 v21, s[26:27]
  s_add_u32 s26, s26, 196608
  s_addc_u32 s27, s27, 0
  ds_read_b128 v[64:67], v60 offset:16384
  ds_read_b128 v[68:71], v61 offset:16384
  ds_read_b128 v[72:75], v60 offset:18432
  ds_read_b128 v[76:79], v61 offset:18432
  s_waitcnt lgkmcnt(0)
  v_mfma_f32_16x16x32_bf16 v[80:83], v[64:67], v[96:99], v[80:83]
  v_mfma_f32_16x16x32_bf16 v[88:91], v[64:67], v[64:67], v[88:91]
  v_mfma_f32_16x16x32_bf16 v[84:87], v[72:75], v[96:99], v[84:87]
  v_mfma_f32_16x16x32_bf16 v[92:95], v[72:75], v[72:75], v[92:95]
  v_mfma_f32_16x16x32_bf16 v[80:83], v[68:71], v[96:99], v[80:83]
  v_mfma_f32_16x16x32_bf16 v[88:91], v[68:71], v[68:71], v[88:91]
  v_mfma_f32_16x16x32_bf16 v[84:87], v[76:79], v[96:99], v[84:87]
  v_mfma_f32_16x16x32_bf16 v[92:95], v[76:79], v[76:79], v[92:95]
  s_waitcnt vmcnt(10)
  s_barrier
  s_add_u32 s45, s30, 16384
  s_add_u32 m0, s45, 0
  s_nop 0
  global_load_lds_dwordx4 v16, s[16:17]
  s_add_u32 m0, s45, 4096
  s_nop 0
  global_load_lds_dwordx4 v17, s[16:17]
  s_add_u32 m0, s45, 8192
  s_nop 0
  global_load_lds_dwordx4 v18, s[16:17]
  s_add_u32 m0, s45, 12288
  s_nop 0
  global_load_lds_dwordx4 v19, s[16:17]
  s_add_u32 s16, s16, 128
  s_addc_u32 s17, s17, 0
  ds_read_b128 v[64:67], v60 offset:0
  ds_read_b128 v[68:71], v61 offset:0
  ds_read_b128 v[72:75], v60 offset:2048
  ds_read_b128 v[76:79], v61 offset:2048
  s_waitcnt lgkmcnt(0)
  v_mfma_f32_16x16x32_bf16 v[80:83], v[64:67], v[96:99], v[80:83]
  v_mfma_f32_16x16x32_bf16 v[88:91], v[64:67], v[64:67], v[88:91]
  v_mfma_f32_16x16x32_bf16 v[84:87], v[72:75], v[96:99], v[84:87]
  v_mfma_f32_16x16x32_bf16 v[92:95], v[72:75], v[72:75], v[92:95]
  v_mfma_f32_16x16x32_bf16 v[80:83], v[68:71], v[96:99], v[80:83]
  v_mfma_f32_16x16x32_bf16 v[88:91], v[68:71], v[68:71], v[88:91]
  v_mfma_f32_16x16x32_bf16 v[84:87], v[76:79], v[96:99], v[84:87]
  v_mfma_f32_16x16x32_bf16 v[92:95], v[76:79], v[76:79], v[92:95]
  s_waitcnt vmcnt(0)
  s_barrier
  ds_read_b128 v[64:67], v60 offset:16384
  ds_read_b128 v[68:71], v61 offset:16384
  ds_read_b128 v[72:75], v60 offset:18432
  ds_read_b128 v[76:79], v61 offset:18432
  s_waitcnt lgkmcnt(0)
  v_mfma_f32_16x16x32_bf16 v[80:83], v[64:67], v[96:99], v[80:83]
  v_mfma_f32_16x16x32_bf16 v[88:91], v[64:67], v[64:67], v[88:91]
  v_mfma_f32_16x16x32_bf16 v[84:87], v[72:75], v[96:99], v[84:87]
  v_mfma_f32_16x16x32_bf16 v[92:95], v[72:75], v[72:75], v[92:95]
  v_mfma_f32_16x16x32_bf16 v[80:83], v[68:71], v[96:99], v[80:83]
  v_mfma_f32_16x16x32_bf16 v[88:91], v[68:71], v[68:71], v[88:91]
  v_mfma_f32_16x16x32_bf16 v[84:87], v[76:79], v[96:99], v[84:87]
  v_mfma_f32_16x16x32_bf16 v[92:95], v[76:79], v[76:79], v[92:95]
  s_waitcnt vmcnt(0)
  s_barrier
  v_and_b32 v24, 3, v1
  v_and_b32 v25, 15, v1
  v_lshrrev_b32 v26, 2, v25
  v_lshrrev_b32 v27, 4, v1
  s_mov_b32 s84, 0x3b000000
  s_mov_b32 s85, 0x3727c5ac
  v_mov_b32 v28, s85
  v_lshlrev_b32 v25, 2, v25
  s_lshl_b32 s82, s14, 7
  s_add_u32 s82, s82, 155648
  v_add_u32 v25, s82, v25
  s_nop 7

  v_cmp_eq_u32 vcc, 1, v24
  v_cndmask_b32 v80, v80, v81, vcc
  v_cndmask_b32 v88, v88, v89, vcc
  v_cmp_eq_u32 vcc, 2, v24
  v_cndmask_b32 v80, v80, v82, vcc
  v_cndmask_b32 v88, v88, v90, vcc
  v_cmp_eq_u32 vcc, 3, v24
  v_cndmask_b32 v80, v80, v83, vcc
  v_cndmask_b32 v88, v88, v91, vcc
  v_mul_f32 v80, s84, v80
  v_fma_f32 v88, v88, s84, v28
  v_fma_f32 v88, -v80, v80, v88
  v_max_f32 v88, v88, v28
  v_rsq_f32 v88, v88
  v_sub_f32 v80, 0, v80

  v_cmp_eq_u32 vcc, 1, v24
  v_cndmask_b32 v84, v84, v85, vcc
  v_cndmask_b32 v92, v92, v93, vcc
  v_cmp_eq_u32 vcc, 2, v24
  v_cndmask_b32 v84, v84, v86, vcc
  v_cndmask_b32 v92, v92, v94, vcc
  v_cmp_eq_u32 vcc, 3, v24
  v_cndmask_b32 v84, v84, v87, vcc
  v_cndmask_b32 v92, v92, v95, vcc
  v_mul_f32 v84, s84, v84
  v_fma_f32 v92, v92, s84, v28
  v_fma_f32 v92, -v84, v84, v92
  v_max_f32 v92, v92, v28
  v_rsq_f32 v92, v92
  v_sub_f32 v84, 0, v84

  v_cmp_eq_u32 vcc, v26, v27
  s_and_saveexec_b64 s[86:87], vcc
  ds_write_b32 v25, v88
  ds_write_b32 v25, v80 offset:512
  ds_write_b32 v25, v92 offset:64
  ds_write_b32 v25, v84 offset:576
  s_mov_b64 exec, s[86:87]
  s_waitcnt lgkmcnt(0)
  s_barrier

gemm1_kernel_end:
  s_endpgm
.section .rodata,"a"
.p2align 6
.amdhsa_kernel gemm1_kernel
  .amdhsa_next_free_vgpr 168
  .amdhsa_next_free_sgpr 102
  .amdhsa_accum_offset 168
  .amdhsa_group_segment_fixed_size 0
  .amdhsa_kernarg_size 80
  .amdhsa_user_sgpr_count 2
  .amdhsa_user_sgpr_kernarg_segment_ptr 1
  .amdhsa_system_sgpr_workgroup_id_x 1
.end_amdhsa_kernel
.text
.globl attn_kernel
.p2align 8
.type attn_kernel,@function
attn_kernel:
  s_cmp_ge_u32 s2, 256
  s_cbranch_scc1 attn_kernel_end
  s_nop 0
  s_nop 0
  s_load_dwordx2 s[4:5], s[0:1], 72
  s_load_dwordx2 s[70:71], s[0:1], 64
  s_load_dwordx2 s[40:41], s[0:1], 0
  s_load_dwordx2 s[42:43], s[0:1], 56
  v_lshrrev_b32 v104, 6, v0
  v_and_b32 v1, 63, v0
  s_and_b32 s3, s2, 7
  v_readfirstlane_b32 s14, v104
  s_lshr_b32 s15, s2, 3
  s_cmp_ge_u32 s14, 8
  s_cbranch_scc1 attn_kernel_gemm
  s_setprio 1
  s_and_b32 s12, s15, 3
  s_lshl_b32 s3, s3, 2
  s_add_u32 s12, s12, s3
  s_lshr_b32 s13, s2, 5
  s_lshl_b32 s13, s13, 3
  s_add_u32 s13, s13, s14
  v_lshlrev_b32 v2, 4, v1
  s_lshl_b32 s16, s12, 16
  s_lshl_b32 s17, s13, 10
  s_lshl_b32 s18, s14, 10
  s_waitcnt lgkmcnt(0)
  s_add_u32 s20, s4, s16
  s_addc_u32 s21, s5, 0
  s_add_u32 s22, s20, s17
  s_addc_u32 s23, s21, 0
  s_add_u32 s22, s22, 2097152
  s_addc_u32 s23, s23, 0
  global_load_dwordx4 v[4:7], v2, s[22:23]
  s_add_u32 s24, s20, s18
  s_addc_u32 s25, s21, 0
  s_add_u32 s26, s24, 6291456
  s_addc_u32 s27, s25, 0
  s_add_u32 s24, s24, 4194304
  s_addc_u32 s25, s25, 0

  s_add_u32 m0, s18, 0
  s_nop 0
  global_load_lds_dwordx4 v2, s[24:25]
  s_add_u32 m0, s18, 65536
  s_nop 0
  global_load_lds_dwordx4 v2, s[26:27]

  s_add_u32 s24, s24, 8192
  s_addc_u32 s25, s25, 0
  s_add_u32 s26, s26, 8192
  s_addc_u32 s27, s27, 0

  s_add_u32 m0, s18, 8192
  s_nop 0
  global_load_lds_dwordx4 v2, s[24:25]
  s_add_u32 m0, s18, 73728
  s_nop 0
  global_load_lds_dwordx4 v2, s[26:27]

  s_add_u32 s24, s24, 8192
  s_addc_u32 s25, s25, 0
  s_add_u32 s26, s26, 8192
  s_addc_u32 s27, s27, 0

  s_add_u32 m0, s18, 16384
  s_nop 0
  global_load_lds_dwordx4 v2, s[24:25]
  s_add_u32 m0, s18, 81920
  s_nop 0
  global_load_lds_dwordx4 v2, s[26:27]

  s_add_u32 s24, s24, 8192
  s_addc_u32 s25, s25, 0
  s_add_u32 s26, s26, 8192
  s_addc_u32 s27, s27, 0

  s_add_u32 m0, s18, 24576
  s_nop 0
  global_load_lds_dwordx4 v2, s[24:25]
  s_add_u32 m0, s18, 90112
  s_nop 0
  global_load_lds_dwordx4 v2, s[26:27]

  s_add_u32 s24, s24, 8192
  s_addc_u32 s25, s25, 0
  s_add_u32 s26, s26, 8192
  s_addc_u32 s27, s27, 0

  s_add_u32 m0, s18, 32768
  s_nop 0
  global_load_lds_dwordx4 v2, s[24:25]
  s_add_u32 m0, s18, 98304
  s_nop 0
  global_load_lds_dwordx4 v2, s[26:27]

  s_add_u32 s24, s24, 8192
  s_addc_u32 s25, s25, 0
  s_add_u32 s26, s26, 8192
  s_addc_u32 s27, s27, 0

  s_add_u32 m0, s18, 40960
  s_nop 0
  global_load_lds_dwordx4 v2, s[24:25]
  s_add_u32 m0, s18, 106496
  s_nop 0
  global_load_lds_dwordx4 v2, s[26:27]

  s_add_u32 s24, s24, 8192
  s_addc_u32 s25, s25, 0
  s_add_u32 s26, s26, 8192
  s_addc_u32 s27, s27, 0

  s_add_u32 m0, s18, 49152
  s_nop 0
  global_load_lds_dwordx4 v2, s[24:25]
  s_add_u32 m0, s18, 114688
  s_nop 0
  global_load_lds_dwordx4 v2, s[26:27]

  s_add_u32 s24, s24, 8192
  s_addc_u32 s25, s25, 0
  s_add_u32 s26, s26, 8192
  s_addc_u32 s27, s27, 0

  s_add_u32 m0, s18, 57344
  s_nop 0
  global_load_lds_dwordx4 v2, s[24:25]
  s_add_u32 m0, s18, 122880
  s_nop 0
  global_load_lds_dwordx4 v2, s[26:27]

  v_lshrrev_b32 v104, 5, v1
  v_and_b32 v105, 15, v1
  v_lshlrev_b32 v105, 4, v105
  v_lshl_add_u32 v3, v104, 8, v105
  v_add_u32 v3, 0x10000, v3
  s_mov_b32 s28, 0x0000ffff
  s_mov_b32 s29, 0x0000ffff

  v_and_b32 v106, 31, v1
  v_mov_b32 v107, 0x3f803f80
  v_cmp_eq_u32 vcc, 16, v106
  v_cndmask_b32 v107, 0, v107, vcc

  v_mov_b32 v16, v107
  v_mov_b32 v17, v107
  v_mov_b32 v18, v107
  v_mov_b32 v19, v107
  v_mov_b32 v20, v107
  v_mov_b32 v21, v107
  v_mov_b32 v22, v107
  v_mov_b32 v23, v107
  v_mov_b32 v24, v107
  v_mov_b32 v25, v107
  v_mov_b32 v26, v107
  v_mov_b32 v27, v107
  v_mov_b32 v28, v107
  v_mov_b32 v29, v107
  v_mov_b32 v30, v107
  v_mov_b32 v31, v107
  v_mov_b32 v72, 0
  v_mov_b32 v73, 0
  v_mov_b32 v74, 0
  v_mov_b32 v75, 0
  v_mov_b32 v76, 0
  v_mov_b32 v77, 0
  v_mov_b32 v78, 0
  v_mov_b32 v79, 0
  v_mov_b32 v80, 0
  v_mov_b32 v81, 0
  v_mov_b32 v82, 0
  v_mov_b32 v83, 0
  v_mov_b32 v84, 0
  v_mov_b32 v85, 0
  v_mov_b32 v86, 0
  v_mov_b32 v87, 0
  s_waitcnt vmcnt(12)
  s_barrier
  ds_read_b128 v[8:11], v2 offset:0
  ds_read_b128 v[12:15], v2 offset:1024
  s_mov_b64 exec, s[28:29]
  ds_read_b128 v[16:19], v3 offset:0
  ds_read_b128 v[20:23], v3 offset:512
  s_mov_b64 exec, -1
  s_waitcnt lgkmcnt(3)
  v_mfma_f32_32x32x16_bf16 v[32:47], v[8:11], v[4:7], 0
  s_nop 15
  v_max3_f32 v104, v32, v33, v34
  v_max3_f32 v104, v104, v35, v36
  v_max3_f32 v104, v104, v37, v38
  v_max3_f32 v104, v104, v39, v40
  v_max3_f32 v104, v104, v41, v42
  v_max3_f32 v104, v104, v43, v44
  v_max3_f32 v104, v104, v45, v46
  v_max_f32 v104, v104, v47
  v_mov_b32 v105, v104
  s_nop 1
  v_permlane32_swap_b32 v104, v105
  s_nop 1
  v_max_f32 v104, v104, v105
  v_add_f32 v104, 0x42b40000, v104
  v_sub_f32 v104, 0, v104

  v_mov_b32 v88, v104
  v_mov_b32 v89, v104
  v_mov_b32 v90, v104
  v_mov_b32 v91, v104
  v_mov_b32 v92, v104
  v_mov_b32 v93, v104
  v_mov_b32 v94, v104
  v_mov_b32 v95, v104
  v_mov_b32 v96, v104
  v_mov_b32 v97, v104
  v_mov_b32 v98, v104
  v_mov_b32 v99, v104
  v_mov_b32 v100, v104
  v_mov_b32 v101, v104
  v_mov_b32 v102, v104
  v_mov_b32 v103, v104
  s_nop 1
  v_mfma_f32_32x32x16_bf16 v[32:47], v[8:11], v[4:7], v[88:103]
  s_nop 15
  v_exp_f32 v32, v32
  v_exp_f32 v33, v33
  v_exp_f32 v34, v34
  v_exp_f32 v35, v35
  s_waitcnt lgkmcnt(2)
  v_mfma_f32_32x32x16_bf16 v[48:63], v[12:15], v[4:7], v[88:103]
  v_exp_f32 v36, v36
  v_exp_f32 v37, v37
  v_exp_f32 v38, v38
  v_exp_f32 v39, v39
  v_cvt_pk_bf16_f32 v64, v32, v33
  v_cvt_pk_bf16_f32 v65, v34, v35
  v_cvt_pk_bf16_f32 v66, v36, v37
  v_cvt_pk_bf16_f32 v67, v38, v39
  ds_read_b128 v[8:11], v2 offset:2048
  s_waitcnt lgkmcnt(1)
  v_mfma_f32_32x32x16_bf16 v[72:87], v[16:19], v[64:67], v[72:87]
  v_exp_f32 v40, v40
  v_exp_f32 v41, v41
  v_exp_f32 v42, v42
  v_exp_f32 v43, v43
  v_exp_f32 v44, v44
  v_exp_f32 v45, v45
  v_exp_f32 v46, v46
  v_exp_f32 v47, v47
  s_mov_b64 exec, s[28:29]
  ds_read_b128 v[24:27], v3 offset:1024
  ds_read_b128 v[28:31], v3 offset:1536
  s_mov_b64 exec, -1
  v_cvt_pk_bf16_f32 v68, v40, v41
  v_cvt_pk_bf16_f32 v69, v42, v43
  v_cvt_pk_bf16_f32 v70, v44, v45
  v_cvt_pk_bf16_f32 v71, v46, v47
  s_nop 1
  v_mfma_f32_32x32x16_bf16 v[72:87], v[20:23], v[68:71], v[72:87]
  v_exp_f32 v48, v48
  v_exp_f32 v49, v49
  v_exp_f32 v50, v50
  v_exp_f32 v51, v51
  s_waitcnt lgkmcnt(2)
  v_mfma_f32_32x32x16_bf16 v[32:47], v[8:11], v[4:7], v[88:103]
  v_exp_f32 v52, v52
  v_exp_f32 v53, v53
  v_exp_f32 v54, v54
  v_exp_f32 v55, v55
  v_cvt_pk_bf16_f32 v64, v48, v49
  v_cvt_pk_bf16_f32 v65, v50, v51
  v_cvt_pk_bf16_f32 v66, v52, v53
  v_cvt_pk_bf16_f32 v67, v54, v55
  ds_read_b128 v[12:15], v2 offset:3072
  s_waitcnt lgkmcnt(1)
  v_mfma_f32_32x32x16_bf16 v[72:87], v[24:27], v[64:67], v[72:87]
  v_exp_f32 v56, v56
  v_exp_f32 v57, v57
  v_exp_f32 v58, v58
  v_exp_f32 v59, v59
  v_exp_f32 v60, v60
  v_exp_f32 v61, v61
  v_exp_f32 v62, v62
  v_exp_f32 v63, v63
  s_mov_b64 exec, s[28:29]
  ds_read_b128 v[16:19], v3 offset:2048
  ds_read_b128 v[20:23], v3 offset:2560
  s_mov_b64 exec, -1
  v_cvt_pk_bf16_f32 v68, v56, v57
  v_cvt_pk_bf16_f32 v69, v58, v59
  v_cvt_pk_bf16_f32 v70, v60, v61
  v_cvt_pk_bf16_f32 v71, v62, v63
  s_nop 1
  v_mfma_f32_32x32x16_bf16 v[72:87], v[28:31], v[68:71], v[72:87]
  v_exp_f32 v32, v32
  v_exp_f32 v33, v33
  v_exp_f32 v34, v34
  v_exp_f32 v35, v35
  s_waitcnt lgkmcnt(2)
  v_mfma_f32_32x32x16_bf16 v[48:63], v[12:15], v[4:7], v[88:103]
  v_exp_f32 v36, v36
  v_exp_f32 v37, v37
  v_exp_f32 v38, v38
  v_exp_f32 v39, v39
  v_cvt_pk_bf16_f32 v64, v32, v33
  v_cvt_pk_bf16_f32 v65, v34, v35
  v_cvt_pk_bf16_f32 v66, v36, v37
  v_cvt_pk_bf16_f32 v67, v38, v39
  ds_read_b128 v[8:11], v2 offset:4096
  s_waitcnt lgkmcnt(1)
  v_mfma_f32_32x32x16_bf16 v[72:87], v[16:19], v[64:67], v[72:87]
  v_exp_f32 v40, v40
  v_exp_f32 v41, v41
  v_exp_f32 v42, v42
  v_exp_f32 v43, v43
  v_exp_f32 v44, v44
  v_exp_f32 v45, v45
  v_exp_f32 v46, v46
  v_exp_f32 v47, v47
  s_mov_b64 exec, s[28:29]
  ds_read_b128 v[24:27], v3 offset:3072
  ds_read_b128 v[28:31], v3 offset:3584
  s_mov_b64 exec, -1
  v_cvt_pk_bf16_f32 v68, v40, v41
  v_cvt_pk_bf16_f32 v69, v42, v43
  v_cvt_pk_bf16_f32 v70, v44, v45
  v_cvt_pk_bf16_f32 v71, v46, v47
  s_nop 1
  v_mfma_f32_32x32x16_bf16 v[72:87], v[20:23], v[68:71], v[72:87]
  v_exp_f32 v48, v48
  v_exp_f32 v49, v49
  v_exp_f32 v50, v50
  v_exp_f32 v51, v51
  s_waitcnt lgkmcnt(2)
  v_mfma_f32_32x32x16_bf16 v[32:47], v[8:11], v[4:7], v[88:103]
  v_exp_f32 v52, v52
  v_exp_f32 v53, v53
  v_exp_f32 v54, v54
  v_exp_f32 v55, v55
  v_cvt_pk_bf16_f32 v64, v48, v49
  v_cvt_pk_bf16_f32 v65, v50, v51
  v_cvt_pk_bf16_f32 v66, v52, v53
  v_cvt_pk_bf16_f32 v67, v54, v55
  ds_read_b128 v[12:15], v2 offset:5120
  s_waitcnt lgkmcnt(1)
  v_mfma_f32_32x32x16_bf16 v[72:87], v[24:27], v[64:67], v[72:87]
  v_exp_f32 v56, v56
  v_exp_f32 v57, v57
  v_exp_f32 v58, v58
  v_exp_f32 v59, v59
  v_exp_f32 v60, v60
  v_exp_f32 v61, v61
  v_exp_f32 v62, v62
  v_exp_f32 v63, v63
  s_mov_b64 exec, s[28:29]
  ds_read_b128 v[16:19], v3 offset:4096
  ds_read_b128 v[20:23], v3 offset:4608
  s_mov_b64 exec, -1
  v_cvt_pk_bf16_f32 v68, v56, v57
  v_cvt_pk_bf16_f32 v69, v58, v59
  v_cvt_pk_bf16_f32 v70, v60, v61
  v_cvt_pk_bf16_f32 v71, v62, v63
  s_nop 1
  v_mfma_f32_32x32x16_bf16 v[72:87], v[28:31], v[68:71], v[72:87]
  v_exp_f32 v32, v32
  v_exp_f32 v33, v33
  v_exp_f32 v34, v34
  v_exp_f32 v35, v35
  s_waitcnt lgkmcnt(2)
  v_mfma_f32_32x32x16_bf16 v[48:63], v[12:15], v[4:7], v[88:103]
  v_exp_f32 v36, v36
  v_exp_f32 v37, v37
  v_exp_f32 v38, v38
  v_exp_f32 v39, v39
  v_cvt_pk_bf16_f32 v64, v32, v33
  v_cvt_pk_bf16_f32 v65, v34, v35
  v_cvt_pk_bf16_f32 v66, v36, v37
  v_cvt_pk_bf16_f32 v67, v38, v39
  ds_read_b128 v[8:11], v2 offset:6144
  s_waitcnt lgkmcnt(1)
  v_mfma_f32_32x32x16_bf16 v[72:87], v[16:19], v[64:67], v[72:87]
  v_exp_f32 v40, v40
  v_exp_f32 v41, v41
  v_exp_f32 v42, v42
  v_exp_f32 v43, v43
  v_exp_f32 v44, v44
  v_exp_f32 v45, v45
  v_exp_f32 v46, v46
  v_exp_f32 v47, v47
  s_mov_b64 exec, s[28:29]
  ds_read_b128 v[24:27], v3 offset:5120
  ds_read_b128 v[28:31], v3 offset:5632
  s_mov_b64 exec, -1
  v_cvt_pk_bf16_f32 v68, v40, v41
  v_cvt_pk_bf16_f32 v69, v42, v43
  v_cvt_pk_bf16_f32 v70, v44, v45
  v_cvt_pk_bf16_f32 v71, v46, v47
  s_nop 1
  v_mfma_f32_32x32x16_bf16 v[72:87], v[20:23], v[68:71], v[72:87]
  v_exp_f32 v48, v48
  v_exp_f32 v49, v49
  v_exp_f32 v50, v50
  v_exp_f32 v51, v51
  s_waitcnt lgkmcnt(2)
  v_mfma_f32_32x32x16_bf16 v[32:47], v[8:11], v[4:7], v[88:103]
  v_exp_f32 v52, v52
  v_exp_f32 v53, v53
  v_exp_f32 v54, v54
  v_exp_f32 v55, v55
  v_cvt_pk_bf16_f32 v64, v48, v49
  v_cvt_pk_bf16_f32 v65, v50, v51
  v_cvt_pk_bf16_f32 v66, v52, v53
  v_cvt_pk_bf16_f32 v67, v54, v55
  ds_read_b128 v[12:15], v2 offset:7168
  s_waitcnt lgkmcnt(1)
  v_mfma_f32_32x32x16_bf16 v[72:87], v[24:27], v[64:67], v[72:87]
  v_exp_f32 v56, v56
  v_exp_f32 v57, v57
  v_exp_f32 v58, v58
  v_exp_f32 v59, v59
  v_exp_f32 v60, v60
  v_exp_f32 v61, v61
  v_exp_f32 v62, v62
  v_exp_f32 v63, v63
  s_mov_b64 exec, s[28:29]
  ds_read_b128 v[16:19], v3 offset:6144
  ds_read_b128 v[20:23], v3 offset:6656
  s_mov_b64 exec, -1
  v_cvt_pk_bf16_f32 v68, v56, v57
  v_cvt_pk_bf16_f32 v69, v58, v59
  v_cvt_pk_bf16_f32 v70, v60, v61
  v_cvt_pk_bf16_f32 v71, v62, v63
  s_nop 1
  v_mfma_f32_32x32x16_bf16 v[72:87], v[28:31], v[68:71], v[72:87]
  v_exp_f32 v32, v32
  v_exp_f32 v33, v33
  v_exp_f32 v34, v34
  v_exp_f32 v35, v35
  s_waitcnt lgkmcnt(2)
  v_mfma_f32_32x32x16_bf16 v[48:63], v[12:15], v[4:7], v[88:103]
  v_exp_f32 v36, v36
  v_exp_f32 v37, v37
  v_exp_f32 v38, v38
  v_exp_f32 v39, v39
  v_cvt_pk_bf16_f32 v64, v32, v33
  v_cvt_pk_bf16_f32 v65, v34, v35
  v_cvt_pk_bf16_f32 v66, v36, v37
  v_cvt_pk_bf16_f32 v67, v38, v39
  ds_read_b128 v[8:11], v2 offset:8192
  s_waitcnt lgkmcnt(1)
  v_mfma_f32_32x32x16_bf16 v[72:87], v[16:19], v[64:67], v[72:87]
  v_exp_f32 v40, v40
  v_exp_f32 v41, v41
  v_exp_f32 v42, v42
  v_exp_f32 v43, v43
  v_exp_f32 v44, v44
  v_exp_f32 v45, v45
  v_exp_f32 v46, v46
  v_exp_f32 v47, v47
  s_mov_b64 exec, s[28:29]
  ds_read_b128 v[24:27], v3 offset:7168
  ds_read_b128 v[28:31], v3 offset:7680
  s_mov_b64 exec, -1
  v_cvt_pk_bf16_f32 v68, v40, v41
  v_cvt_pk_bf16_f32 v69, v42, v43
  v_cvt_pk_bf16_f32 v70, v44, v45
  v_cvt_pk_bf16_f32 v71, v46, v47
  s_nop 1
  v_mfma_f32_32x32x16_bf16 v[72:87], v[20:23], v[68:71], v[72:87]
  v_exp_f32 v48, v48
  v_exp_f32 v49, v49
  v_exp_f32 v50, v50
  v_exp_f32 v51, v51
  s_waitcnt lgkmcnt(2)
  v_mfma_f32_32x32x16_bf16 v[32:47], v[8:11], v[4:7], v[88:103]
  v_exp_f32 v52, v52
  v_exp_f32 v53, v53
  v_exp_f32 v54, v54
  v_exp_f32 v55, v55
  v_cvt_pk_bf16_f32 v64, v48, v49
  v_cvt_pk_bf16_f32 v65, v50, v51
  v_cvt_pk_bf16_f32 v66, v52, v53
  v_cvt_pk_bf16_f32 v67, v54, v55
  ds_read_b128 v[12:15], v2 offset:9216
  s_waitcnt lgkmcnt(1)
  v_mfma_f32_32x32x16_bf16 v[72:87], v[24:27], v[64:67], v[72:87]
  v_exp_f32 v56, v56
  v_exp_f32 v57, v57
  v_exp_f32 v58, v58
  v_exp_f32 v59, v59
  v_exp_f32 v60, v60
  v_exp_f32 v61, v61
  v_exp_f32 v62, v62
  v_exp_f32 v63, v63
  s_mov_b64 exec, s[28:29]
  ds_read_b128 v[16:19], v3 offset:8192
  ds_read_b128 v[20:23], v3 offset:8704
  s_mov_b64 exec, -1
  v_cvt_pk_bf16_f32 v68, v56, v57
  v_cvt_pk_bf16_f32 v69, v58, v59
  v_cvt_pk_bf16_f32 v70, v60, v61
  v_cvt_pk_bf16_f32 v71, v62, v63
  s_nop 1
  v_mfma_f32_32x32x16_bf16 v[72:87], v[28:31], v[68:71], v[72:87]
  v_exp_f32 v32, v32
  v_exp_f32 v33, v33
  v_exp_f32 v34, v34
  v_exp_f32 v35, v35
  s_waitcnt lgkmcnt(2)
  v_mfma_f32_32x32x16_bf16 v[48:63], v[12:15], v[4:7], v[88:103]
  v_exp_f32 v36, v36
  v_exp_f32 v37, v37
  v_exp_f32 v38, v38
  v_exp_f32 v39, v39
  v_cvt_pk_bf16_f32 v64, v32, v33
  v_cvt_pk_bf16_f32 v65, v34, v35
  v_cvt_pk_bf16_f32 v66, v36, v37
  v_cvt_pk_bf16_f32 v67, v38, v39
  ds_read_b128 v[8:11], v2 offset:10240
  s_waitcnt lgkmcnt(1)
  v_mfma_f32_32x32x16_bf16 v[72:87], v[16:19], v[64:67], v[72:87]
  v_exp_f32 v40, v40
  v_exp_f32 v41, v41
  v_exp_f32 v42, v42
  v_exp_f32 v43, v43
  v_exp_f32 v44, v44
  v_exp_f32 v45, v45
  v_exp_f32 v46, v46
  v_exp_f32 v47, v47
  s_mov_b64 exec, s[28:29]
  ds_read_b128 v[24:27], v3 offset:9216
  ds_read_b128 v[28:31], v3 offset:9728
  s_mov_b64 exec, -1
  v_cvt_pk_bf16_f32 v68, v40, v41
  v_cvt_pk_bf16_f32 v69, v42, v43
  v_cvt_pk_bf16_f32 v70, v44, v45
  v_cvt_pk_bf16_f32 v71, v46, v47
  s_nop 1
  v_mfma_f32_32x32x16_bf16 v[72:87], v[20:23], v[68:71], v[72:87]
  v_exp_f32 v48, v48
  v_exp_f32 v49, v49
  v_exp_f32 v50, v50
  v_exp_f32 v51, v51
  s_waitcnt lgkmcnt(2)
  v_mfma_f32_32x32x16_bf16 v[32:47], v[8:11], v[4:7], v[88:103]
  v_exp_f32 v52, v52
  v_exp_f32 v53, v53
  v_exp_f32 v54, v54
  v_exp_f32 v55, v55
  v_cvt_pk_bf16_f32 v64, v48, v49
  v_cvt_pk_bf16_f32 v65, v50, v51
  v_cvt_pk_bf16_f32 v66, v52, v53
  v_cvt_pk_bf16_f32 v67, v54, v55
  ds_read_b128 v[12:15], v2 offset:11264
  s_waitcnt lgkmcnt(1)
  v_mfma_f32_32x32x16_bf16 v[72:87], v[24:27], v[64:67], v[72:87]
  v_exp_f32 v56, v56
  v_exp_f32 v57, v57
  v_exp_f32 v58, v58
  v_exp_f32 v59, v59
  v_exp_f32 v60, v60
  v_exp_f32 v61, v61
  v_exp_f32 v62, v62
  v_exp_f32 v63, v63
  s_mov_b64 exec, s[28:29]
  ds_read_b128 v[16:19], v3 offset:10240
  ds_read_b128 v[20:23], v3 offset:10752
  s_mov_b64 exec, -1
  v_cvt_pk_bf16_f32 v68, v56, v57
  v_cvt_pk_bf16_f32 v69, v58, v59
  v_cvt_pk_bf16_f32 v70, v60, v61
  v_cvt_pk_bf16_f32 v71, v62, v63
  s_nop 1
  v_mfma_f32_32x32x16_bf16 v[72:87], v[28:31], v[68:71], v[72:87]
  v_exp_f32 v32, v32
  v_exp_f32 v33, v33
  v_exp_f32 v34, v34
  v_exp_f32 v35, v35
  s_waitcnt lgkmcnt(2)
  v_mfma_f32_32x32x16_bf16 v[48:63], v[12:15], v[4:7], v[88:103]
  v_exp_f32 v36, v36
  v_exp_f32 v37, v37
  v_exp_f32 v38, v38
  v_exp_f32 v39, v39
  v_cvt_pk_bf16_f32 v64, v32, v33
  v_cvt_pk_bf16_f32 v65, v34, v35
  v_cvt_pk_bf16_f32 v66, v36, v37
  v_cvt_pk_bf16_f32 v67, v38, v39
  ds_read_b128 v[8:11], v2 offset:12288
  s_waitcnt lgkmcnt(1)
  v_mfma_f32_32x32x16_bf16 v[72:87], v[16:19], v[64:67], v[72:87]
  v_exp_f32 v40, v40
  v_exp_f32 v41, v41
  v_exp_f32 v42, v42
  v_exp_f32 v43, v43
  v_exp_f32 v44, v44
  v_exp_f32 v45, v45
  v_exp_f32 v46, v46
  v_exp_f32 v47, v47
  s_mov_b64 exec, s[28:29]
  ds_read_b128 v[24:27], v3 offset:11264
  ds_read_b128 v[28:31], v3 offset:11776
  s_mov_b64 exec, -1
  v_cvt_pk_bf16_f32 v68, v40, v41
  v_cvt_pk_bf16_f32 v69, v42, v43
  v_cvt_pk_bf16_f32 v70, v44, v45
  v_cvt_pk_bf16_f32 v71, v46, v47
  s_nop 1
  v_mfma_f32_32x32x16_bf16 v[72:87], v[20:23], v[68:71], v[72:87]
  v_exp_f32 v48, v48
  v_exp_f32 v49, v49
  v_exp_f32 v50, v50
  v_exp_f32 v51, v51
  s_waitcnt lgkmcnt(2)
  v_mfma_f32_32x32x16_bf16 v[32:47], v[8:11], v[4:7], v[88:103]
  v_exp_f32 v52, v52
  v_exp_f32 v53, v53
  v_exp_f32 v54, v54
  v_exp_f32 v55, v55
  v_cvt_pk_bf16_f32 v64, v48, v49
  v_cvt_pk_bf16_f32 v65, v50, v51
  v_cvt_pk_bf16_f32 v66, v52, v53
  v_cvt_pk_bf16_f32 v67, v54, v55
  ds_read_b128 v[12:15], v2 offset:13312
  s_waitcnt lgkmcnt(1)
  v_mfma_f32_32x32x16_bf16 v[72:87], v[24:27], v[64:67], v[72:87]
  v_exp_f32 v56, v56
  v_exp_f32 v57, v57
  v_exp_f32 v58, v58
  v_exp_f32 v59, v59
  v_exp_f32 v60, v60
  v_exp_f32 v61, v61
  v_exp_f32 v62, v62
  v_exp_f32 v63, v63
  s_mov_b64 exec, s[28:29]
  ds_read_b128 v[16:19], v3 offset:12288
  ds_read_b128 v[20:23], v3 offset:12800
  s_mov_b64 exec, -1
  v_cvt_pk_bf16_f32 v68, v56, v57
  v_cvt_pk_bf16_f32 v69, v58, v59
  v_cvt_pk_bf16_f32 v70, v60, v61
  v_cvt_pk_bf16_f32 v71, v62, v63
  s_nop 1
  v_mfma_f32_32x32x16_bf16 v[72:87], v[28:31], v[68:71], v[72:87]
  v_exp_f32 v32, v32
  v_exp_f32 v33, v33
  v_exp_f32 v34, v34
  v_exp_f32 v35, v35
  s_waitcnt lgkmcnt(2)
  v_mfma_f32_32x32x16_bf16 v[48:63], v[12:15], v[4:7], v[88:103]
  v_exp_f32 v36, v36
  v_exp_f32 v37, v37
  v_exp_f32 v38, v38
  v_exp_f32 v39, v39
  v_cvt_pk_bf16_f32 v64, v32, v33
  v_cvt_pk_bf16_f32 v65, v34, v35
  v_cvt_pk_bf16_f32 v66, v36, v37
  v_cvt_pk_bf16_f32 v67, v38, v39
  ds_read_b128 v[8:11], v2 offset:14336
  s_waitcnt lgkmcnt(1)
  v_mfma_f32_32x32x16_bf16 v[72:87], v[16:19], v[64:67], v[72:87]
  v_exp_f32 v40, v40
  v_exp_f32 v41, v41
  v_exp_f32 v42, v42
  v_exp_f32 v43, v43
  v_exp_f32 v44, v44
  v_exp_f32 v45, v45
  v_exp_f32 v46, v46
  v_exp_f32 v47, v47
  s_mov_b64 exec, s[28:29]
  ds_read_b128 v[24:27], v3 offset:13312
  ds_read_b128 v[28:31], v3 offset:13824
  s_mov_b64 exec, -1
  v_cvt_pk_bf16_f32 v68, v40, v41
  v_cvt_pk_bf16_f32 v69, v42, v43
  v_cvt_pk_bf16_f32 v70, v44, v45
  v_cvt_pk_bf16_f32 v71, v46, v47
  s_nop 1
  v_mfma_f32_32x32x16_bf16 v[72:87], v[20:23], v[68:71], v[72:87]
  v_exp_f32 v48, v48
  v_exp_f32 v49, v49
  v_exp_f32 v50, v50
  v_exp_f32 v51, v51
  s_waitcnt lgkmcnt(2)
  v_mfma_f32_32x32x16_bf16 v[32:47], v[8:11], v[4:7], v[88:103]
  v_exp_f32 v52, v52
  v_exp_f32 v53, v53
  v_exp_f32 v54, v54
  v_exp_f32 v55, v55
  v_cvt_pk_bf16_f32 v64, v48, v49
  v_cvt_pk_bf16_f32 v65, v50, v51
  v_cvt_pk_bf16_f32 v66, v52, v53
  v_cvt_pk_bf16_f32 v67, v54, v55
  ds_read_b128 v[12:15], v2 offset:15360
  s_waitcnt lgkmcnt(1)
  v_mfma_f32_32x32x16_bf16 v[72:87], v[24:27], v[64:67], v[72:87]
  v_exp_f32 v56, v56
  v_exp_f32 v57, v57
  v_exp_f32 v58, v58
  v_exp_f32 v59, v59
  v_exp_f32 v60, v60
  v_exp_f32 v61, v61
  v_exp_f32 v62, v62
  v_exp_f32 v63, v63
  s_mov_b64 exec, s[28:29]
  ds_read_b128 v[16:19], v3 offset:14336
  ds_read_b128 v[20:23], v3 offset:14848
  s_mov_b64 exec, -1
  v_cvt_pk_bf16_f32 v68, v56, v57
  v_cvt_pk_bf16_f32 v69, v58, v59
  v_cvt_pk_bf16_f32 v70, v60, v61
  v_cvt_pk_bf16_f32 v71, v62, v63
  s_nop 1
  v_mfma_f32_32x32x16_bf16 v[72:87], v[28:31], v[68:71], v[72:87]
  s_waitcnt vmcnt(0)
  s_barrier
  v_exp_f32 v32, v32
  v_exp_f32 v33, v33
  v_exp_f32 v34, v34
  v_exp_f32 v35, v35
  s_waitcnt lgkmcnt(2)
  v_mfma_f32_32x32x16_bf16 v[48:63], v[12:15], v[4:7], v[88:103]
  v_exp_f32 v36, v36
  v_exp_f32 v37, v37
  v_exp_f32 v38, v38
  v_exp_f32 v39, v39
  v_cvt_pk_bf16_f32 v64, v32, v33
  v_cvt_pk_bf16_f32 v65, v34, v35
  v_cvt_pk_bf16_f32 v66, v36, v37
  v_cvt_pk_bf16_f32 v67, v38, v39
  ds_read_b128 v[8:11], v2 offset:16384
  s_waitcnt lgkmcnt(1)
  v_mfma_f32_32x32x16_bf16 v[72:87], v[16:19], v[64:67], v[72:87]
  v_exp_f32 v40, v40
  v_exp_f32 v41, v41
  v_exp_f32 v42, v42
  v_exp_f32 v43, v43
  v_exp_f32 v44, v44
  v_exp_f32 v45, v45
  v_exp_f32 v46, v46
  v_exp_f32 v47, v47
  s_mov_b64 exec, s[28:29]
  ds_read_b128 v[24:27], v3 offset:15360
  ds_read_b128 v[28:31], v3 offset:15872
  s_mov_b64 exec, -1
  v_cvt_pk_bf16_f32 v68, v40, v41
  v_cvt_pk_bf16_f32 v69, v42, v43
  v_cvt_pk_bf16_f32 v70, v44, v45
  v_cvt_pk_bf16_f32 v71, v46, v47
  s_nop 1
  v_mfma_f32_32x32x16_bf16 v[72:87], v[20:23], v[68:71], v[72:87]
  v_exp_f32 v48, v48
  v_exp_f32 v49, v49
  v_exp_f32 v50, v50
  v_exp_f32 v51, v51
  s_waitcnt lgkmcnt(2)
  v_mfma_f32_32x32x16_bf16 v[32:47], v[8:11], v[4:7], v[88:103]
  v_exp_f32 v52, v52
  v_exp_f32 v53, v53
  v_exp_f32 v54, v54
  v_exp_f32 v55, v55
  v_cvt_pk_bf16_f32 v64, v48, v49
  v_cvt_pk_bf16_f32 v65, v50, v51
  v_cvt_pk_bf16_f32 v66, v52, v53
  v_cvt_pk_bf16_f32 v67, v54, v55
  ds_read_b128 v[12:15], v2 offset:17408
  s_waitcnt lgkmcnt(1)
  v_mfma_f32_32x32x16_bf16 v[72:87], v[24:27], v[64:67], v[72:87]
  v_exp_f32 v56, v56
  v_exp_f32 v57, v57
  v_exp_f32 v58, v58
  v_exp_f32 v59, v59
  v_exp_f32 v60, v60
  v_exp_f32 v61, v61
  v_exp_f32 v62, v62
  v_exp_f32 v63, v63
  s_mov_b64 exec, s[28:29]
  ds_read_b128 v[16:19], v3 offset:16384
  ds_read_b128 v[20:23], v3 offset:16896
  s_mov_b64 exec, -1
  v_cvt_pk_bf16_f32 v68, v56, v57
  v_cvt_pk_bf16_f32 v69, v58, v59
  v_cvt_pk_bf16_f32 v70, v60, v61
  v_cvt_pk_bf16_f32 v71, v62, v63
  s_nop 1
  v_mfma_f32_32x32x16_bf16 v[72:87], v[28:31], v[68:71], v[72:87]
  v_add_u32 v2, 16384, v2
  v_add_u32 v3, 16384, v3
  s_mov_b32 s30, 6

attn_kernel_loop:
  v_exp_f32 v32, v32
  v_exp_f32 v33, v33
  v_exp_f32 v34, v34
  v_exp_f32 v35, v35
  s_waitcnt lgkmcnt(2)
  v_mfma_f32_32x32x16_bf16 v[48:63], v[12:15], v[4:7], v[88:103]
  v_exp_f32 v36, v36
  v_exp_f32 v37, v37
  v_exp_f32 v38, v38
  v_exp_f32 v39, v39
  v_cvt_pk_bf16_f32 v64, v32, v33
  v_cvt_pk_bf16_f32 v65, v34, v35
  v_cvt_pk_bf16_f32 v66, v36, v37
  v_cvt_pk_bf16_f32 v67, v38, v39
  ds_read_b128 v[8:11], v2 offset:2048
  s_waitcnt lgkmcnt(1)
  v_mfma_f32_32x32x16_bf16 v[72:87], v[16:19], v[64:67], v[72:87]
  v_exp_f32 v40, v40
  v_exp_f32 v41, v41
  v_exp_f32 v42, v42
  v_exp_f32 v43, v43
  v_exp_f32 v44, v44
  v_exp_f32 v45, v45
  v_exp_f32 v46, v46
  v_exp_f32 v47, v47
  s_mov_b64 exec, s[28:29]
  ds_read_b128 v[24:27], v3 offset:1024
  ds_read_b128 v[28:31], v3 offset:1536
  s_mov_b64 exec, -1
  v_cvt_pk_bf16_f32 v68, v40, v41
  v_cvt_pk_bf16_f32 v69, v42, v43
  v_cvt_pk_bf16_f32 v70, v44, v45
  v_cvt_pk_bf16_f32 v71, v46, v47
  s_nop 1
  v_mfma_f32_32x32x16_bf16 v[72:87], v[20:23], v[68:71], v[72:87]
  v_exp_f32 v48, v48
  v_exp_f32 v49, v49
  v_exp_f32 v50, v50
  v_exp_f32 v51, v51
  s_waitcnt lgkmcnt(2)
  v_mfma_f32_32x32x16_bf16 v[32:47], v[8:11], v[4:7], v[88:103]
  v_exp_f32 v52, v52
  v_exp_f32 v53, v53
  v_exp_f32 v54, v54
  v_exp_f32 v55, v55
  v_cvt_pk_bf16_f32 v64, v48, v49
  v_cvt_pk_bf16_f32 v65, v50, v51
  v_cvt_pk_bf16_f32 v66, v52, v53
  v_cvt_pk_bf16_f32 v67, v54, v55
  ds_read_b128 v[12:15], v2 offset:3072
  s_waitcnt lgkmcnt(1)
  v_mfma_f32_32x32x16_bf16 v[72:87], v[24:27], v[64:67], v[72:87]
  v_exp_f32 v56, v56
  v_exp_f32 v57, v57
  v_exp_f32 v58, v58
  v_exp_f32 v59, v59
  v_exp_f32 v60, v60
  v_exp_f32 v61, v61
  v_exp_f32 v62, v62
  v_exp_f32 v63, v63
  s_mov_b64 exec, s[28:29]
  ds_read_b128 v[16:19], v3 offset:2048
  ds_read_b128 v[20:23], v3 offset:2560
  s_mov_b64 exec, -1
  v_cvt_pk_bf16_f32 v68, v56, v57
  v_cvt_pk_bf16_f32 v69, v58, v59
  v_cvt_pk_bf16_f32 v70, v60, v61
  v_cvt_pk_bf16_f32 v71, v62, v63
  s_nop 1
  v_mfma_f32_32x32x16_bf16 v[72:87], v[28:31], v[68:71], v[72:87]
  s_cmp_lg_u32 s30, 5
  s_cbranch_scc1 attn_kernel_nosw
  s_cmp_lt_u32 s14, 4
  s_cbranch_scc1 attn_kernel_nosw
  s_setprio 2
  attn_kernel_nosw:

  v_exp_f32 v32, v32
  v_exp_f32 v33, v33
  v_exp_f32 v34, v34
  v_exp_f32 v35, v35
  s_waitcnt lgkmcnt(2)
  v_mfma_f32_32x32x16_bf16 v[48:63], v[12:15], v[4:7], v[88:103]
  v_exp_f32 v36, v36
  v_exp_f32 v37, v37
  v_exp_f32 v38, v38
  v_exp_f32 v39, v39
  v_cvt_pk_bf16_f32 v64, v32, v33
  v_cvt_pk_bf16_f32 v65, v34, v35
  v_cvt_pk_bf16_f32 v66, v36, v37
  v_cvt_pk_bf16_f32 v67, v38, v39
  ds_read_b128 v[8:11], v2 offset:4096
  s_waitcnt lgkmcnt(1)
  v_mfma_f32_32x32x16_bf16 v[72:87], v[16:19], v[64:67], v[72:87]
  v_exp_f32 v40, v40
  v_exp_f32 v41, v41
  v_exp_f32 v42, v42
  v_exp_f32 v43, v43
  v_exp_f32 v44, v44
  v_exp_f32 v45, v45
  v_exp_f32 v46, v46
  v_exp_f32 v47, v47
  s_mov_b64 exec, s[28:29]
  ds_read_b128 v[24:27], v3 offset:3072
  ds_read_b128 v[28:31], v3 offset:3584
  s_mov_b64 exec, -1
  v_cvt_pk_bf16_f32 v68, v40, v41
  v_cvt_pk_bf16_f32 v69, v42, v43
  v_cvt_pk_bf16_f32 v70, v44, v45
  v_cvt_pk_bf16_f32 v71, v46, v47
  s_nop 1
  v_mfma_f32_32x32x16_bf16 v[72:87], v[20:23], v[68:71], v[72:87]
  v_exp_f32 v48, v48
  v_exp_f32 v49, v49
  v_exp_f32 v50, v50
  v_exp_f32 v51, v51
  s_waitcnt lgkmcnt(2)
  v_mfma_f32_32x32x16_bf16 v[32:47], v[8:11], v[4:7], v[88:103]
  v_exp_f32 v52, v52
  v_exp_f32 v53, v53
  v_exp_f32 v54, v54
  v_exp_f32 v55, v55
  v_cvt_pk_bf16_f32 v64, v48, v49
  v_cvt_pk_bf16_f32 v65, v50, v51
  v_cvt_pk_bf16_f32 v66, v52, v53
  v_cvt_pk_bf16_f32 v67, v54, v55
  ds_read_b128 v[12:15], v2 offset:5120
  s_waitcnt lgkmcnt(1)
  v_mfma_f32_32x32x16_bf16 v[72:87], v[24:27], v[64:67], v[72:87]
  v_exp_f32 v56, v56
  v_exp_f32 v57, v57
  v_exp_f32 v58, v58
  v_exp_f32 v59, v59
  v_exp_f32 v60, v60
  v_exp_f32 v61, v61
  v_exp_f32 v62, v62
  v_exp_f32 v63, v63
  s_mov_b64 exec, s[28:29]
  ds_read_b128 v[16:19], v3 offset:4096
  ds_read_b128 v[20:23], v3 offset:4608
  s_mov_b64 exec, -1
  v_cvt_pk_bf16_f32 v68, v56, v57
  v_cvt_pk_bf16_f32 v69, v58, v59
  v_cvt_pk_bf16_f32 v70, v60, v61
  v_cvt_pk_bf16_f32 v71, v62, v63
  s_nop 1
  v_mfma_f32_32x32x16_bf16 v[72:87], v[28:31], v[68:71], v[72:87]
  v_exp_f32 v32, v32
  v_exp_f32 v33, v33
  v_exp_f32 v34, v34
  v_exp_f32 v35, v35
  s_waitcnt lgkmcnt(2)
  v_mfma_f32_32x32x16_bf16 v[48:63], v[12:15], v[4:7], v[88:103]
  v_exp_f32 v36, v36
  v_exp_f32 v37, v37
  v_exp_f32 v38, v38
  v_exp_f32 v39, v39
  v_cvt_pk_bf16_f32 v64, v32, v33
  v_cvt_pk_bf16_f32 v65, v34, v35
  v_cvt_pk_bf16_f32 v66, v36, v37
  v_cvt_pk_bf16_f32 v67, v38, v39
  ds_read_b128 v[8:11], v2 offset:6144
  s_waitcnt lgkmcnt(1)
  v_mfma_f32_32x32x16_bf16 v[72:87], v[16:19], v[64:67], v[72:87]
  v_exp_f32 v40, v40
  v_exp_f32 v41, v41
  v_exp_f32 v42, v42
  v_exp_f32 v43, v43
  v_exp_f32 v44, v44
  v_exp_f32 v45, v45
  v_exp_f32 v46, v46
  v_exp_f32 v47, v47
  s_mov_b64 exec, s[28:29]
  ds_read_b128 v[24:27], v3 offset:5120
  ds_read_b128 v[28:31], v3 offset:5632
  s_mov_b64 exec, -1
  v_cvt_pk_bf16_f32 v68, v40, v41
  v_cvt_pk_bf16_f32 v69, v42, v43
  v_cvt_pk_bf16_f32 v70, v44, v45
  v_cvt_pk_bf16_f32 v71, v46, v47
  s_nop 1
  v_mfma_f32_32x32x16_bf16 v[72:87], v[20:23], v[68:71], v[72:87]
  v_exp_f32 v48, v48
  v_exp_f32 v49, v49
  v_exp_f32 v50, v50
  v_exp_f32 v51, v51
  s_waitcnt lgkmcnt(2)
  v_mfma_f32_32x32x16_bf16 v[32:47], v[8:11], v[4:7], v[88:103]
  v_exp_f32 v52, v52
  v_exp_f32 v53, v53
  v_exp_f32 v54, v54
  v_exp_f32 v55, v55
  v_cvt_pk_bf16_f32 v64, v48, v49
  v_cvt_pk_bf16_f32 v65, v50, v51
  v_cvt_pk_bf16_f32 v66, v52, v53
  v_cvt_pk_bf16_f32 v67, v54, v55
  ds_read_b128 v[12:15], v2 offset:7168
  s_waitcnt lgkmcnt(1)
  v_mfma_f32_32x32x16_bf16 v[72:87], v[24:27], v[64:67], v[72:87]
  v_exp_f32 v56, v56
  v_exp_f32 v57, v57
  v_exp_f32 v58, v58
  v_exp_f32 v59, v59
  v_exp_f32 v60, v60
  v_exp_f32 v61, v61
  v_exp_f32 v62, v62
  v_exp_f32 v63, v63
  s_mov_b64 exec, s[28:29]
  ds_read_b128 v[16:19], v3 offset:6144
  ds_read_b128 v[20:23], v3 offset:6656
  s_mov_b64 exec, -1
  v_cvt_pk_bf16_f32 v68, v56, v57
  v_cvt_pk_bf16_f32 v69, v58, v59
  v_cvt_pk_bf16_f32 v70, v60, v61
  v_cvt_pk_bf16_f32 v71, v62, v63
  s_nop 1
  v_mfma_f32_32x32x16_bf16 v[72:87], v[28:31], v[68:71], v[72:87]
  v_exp_f32 v32, v32
  v_exp_f32 v33, v33
  v_exp_f32 v34, v34
  v_exp_f32 v35, v35
  s_waitcnt lgkmcnt(2)
  v_mfma_f32_32x32x16_bf16 v[48:63], v[12:15], v[4:7], v[88:103]
  v_exp_f32 v36, v36
  v_exp_f32 v37, v37
  v_exp_f32 v38, v38
  v_exp_f32 v39, v39
  v_cvt_pk_bf16_f32 v64, v32, v33
  v_cvt_pk_bf16_f32 v65, v34, v35
  v_cvt_pk_bf16_f32 v66, v36, v37
  v_cvt_pk_bf16_f32 v67, v38, v39
  ds_read_b128 v[8:11], v2 offset:8192
  s_waitcnt lgkmcnt(1)
  v_mfma_f32_32x32x16_bf16 v[72:87], v[16:19], v[64:67], v[72:87]
  v_exp_f32 v40, v40
  v_exp_f32 v41, v41
  v_exp_f32 v42, v42
  v_exp_f32 v43, v43
  v_exp_f32 v44, v44
  v_exp_f32 v45, v45
  v_exp_f32 v46, v46
  v_exp_f32 v47, v47
  s_mov_b64 exec, s[28:29]
  ds_read_b128 v[24:27], v3 offset:7168
  ds_read_b128 v[28:31], v3 offset:7680
  s_mov_b64 exec, -1
  v_cvt_pk_bf16_f32 v68, v40, v41
  v_cvt_pk_bf16_f32 v69, v42, v43
  v_cvt_pk_bf16_f32 v70, v44, v45
  v_cvt_pk_bf16_f32 v71, v46, v47
  s_nop 1
  v_mfma_f32_32x32x16_bf16 v[72:87], v[20:23], v[68:71], v[72:87]
  v_exp_f32 v48, v48
  v_exp_f32 v49, v49
  v_exp_f32 v50, v50
  v_exp_f32 v51, v51
  s_waitcnt lgkmcnt(2)
  v_mfma_f32_32x32x16_bf16 v[32:47], v[8:11], v[4:7], v[88:103]
  v_exp_f32 v52, v52
  v_exp_f32 v53, v53
  v_exp_f32 v54, v54
  v_exp_f32 v55, v55
  v_cvt_pk_bf16_f32 v64, v48, v49
  v_cvt_pk_bf16_f32 v65, v50, v51
  v_cvt_pk_bf16_f32 v66, v52, v53
  v_cvt_pk_bf16_f32 v67, v54, v55
  ds_read_b128 v[12:15], v2 offset:9216
  s_waitcnt lgkmcnt(1)
  v_mfma_f32_32x32x16_bf16 v[72:87], v[24:27], v[64:67], v[72:87]
  v_exp_f32 v56, v56
  v_exp_f32 v57, v57
  v_exp_f32 v58, v58
  v_exp_f32 v59, v59
  v_exp_f32 v60, v60
  v_exp_f32 v61, v61
  v_exp_f32 v62, v62
  v_exp_f32 v63, v63
  s_mov_b64 exec, s[28:29]
  ds_read_b128 v[16:19], v3 offset:8192
  ds_read_b128 v[20:23], v3 offset:8704
  s_mov_b64 exec, -1
  v_cvt_pk_bf16_f32 v68, v56, v57
  v_cvt_pk_bf16_f32 v69, v58, v59
  v_cvt_pk_bf16_f32 v70, v60, v61
  v_cvt_pk_bf16_f32 v71, v62, v63
  s_nop 1
  v_mfma_f32_32x32x16_bf16 v[72:87], v[28:31], v[68:71], v[72:87]
  v_add_u32 v2, 8192, v2
  v_add_u32 v3, 8192, v3
  s_sub_u32 s30, s30, 1

  s_cmp_lg_u32 s30, 0
  s_cbranch_scc1 attn_kernel_loop
  s_nop 15
  s_waitcnt lgkmcnt(0)

  v_mov_b32 v107, v80
  s_nop 1
  v_permlane32_swap_b32 v80, v107
  s_mov_b32 s31, 0x7e800000
  s_mov_b32 s30, 0x77800000
  v_cmp_gt_f32 vcc, s30, v80
  s_mov_b64 s[32:33], vcc

  v_cmp_gt_f32 vcc, s31, abs(v72)
  s_and_b64 s[32:33], s[32:33], vcc
  v_cmp_gt_f32 vcc, s31, abs(v73)
  s_and_b64 s[32:33], s[32:33], vcc
  v_cmp_gt_f32 vcc, s31, abs(v74)
  s_and_b64 s[32:33], s[32:33], vcc
  v_cmp_gt_f32 vcc, s31, abs(v75)
  s_and_b64 s[32:33], s[32:33], vcc
  v_cmp_gt_f32 vcc, s31, abs(v76)
  s_and_b64 s[32:33], s[32:33], vcc
  v_cmp_gt_f32 vcc, s31, abs(v77)
  s_and_b64 s[32:33], s[32:33], vcc
  v_cmp_gt_f32 vcc, s31, abs(v78)
  s_and_b64 s[32:33], s[32:33], vcc
  v_cmp_gt_f32 vcc, s31, abs(v79)
  s_and_b64 s[32:33], s[32:33], vcc
  s_cmp_eq_u64 s[32:33], -1
  s_cbranch_scc0 attn_kernel_fallback
  attn_kernel_final:
  v_rcp_f32 v104, v80
  v_and_b32 v105, 31, v1
  v_lshrrev_b32 v106, 5, v1
  v_lshlrev_b32 v105, 4, v105
  v_lshl_add_u32 v105, v106, 3, v105
  s_lshl_b32 s16, s13, 5
  s_add_u32 s16, s16, s12
  s_lshl_b32 s16, s16, 10
  s_add_u32 s16, s16, 16777216
  s_add_u32 s16, s4, s16
  s_addc_u32 s17, s5, 0

  v_mul_f32 v72, v72, v104
  v_mul_f32 v73, v73, v104
  v_mul_f32 v74, v74, v104
  v_mul_f32 v75, v75, v104
  v_mul_f32 v76, v76, v104
  v_mul_f32 v77, v77, v104
  v_mul_f32 v78, v78, v104
  v_mul_f32 v79, v79, v104
  v_cvt_pk_bf16_f32 v64, v72, v73
  v_cvt_pk_bf16_f32 v65, v74, v75
  v_cvt_pk_bf16_f32 v66, v76, v77
  v_cvt_pk_bf16_f32 v67, v78, v79
  global_store_dwordx2 v105, v[64:65], s[16:17]
  global_store_dwordx2 v105, v[66:67], s[16:17] offset:512

  s_endpgm
attn_kernel_fallback:
  v_lshlrev_b32 v2, 4, v1
  v_lshrrev_b32 v104, 5, v1
  v_and_b32 v105, 15, v1
  v_lshlrev_b32 v105, 4, v105
  v_lshl_add_u32 v3, v104, 8, v105
  v_add_u32 v3, 0x10000, v3
  v_mov_b32 v88, 0xff7fffff
  s_mov_b32 s30, 0

  v_mov_b32 v72, 0
  v_mov_b32 v73, 0
  v_mov_b32 v74, 0
  v_mov_b32 v75, 0
  v_mov_b32 v76, 0
  v_mov_b32 v77, 0
  v_mov_b32 v78, 0
  v_mov_b32 v79, 0
  v_mov_b32 v80, 0
  v_mov_b32 v81, 0
  v_mov_b32 v82, 0
  v_mov_b32 v83, 0
  v_mov_b32 v84, 0
  v_mov_b32 v85, 0
  v_mov_b32 v86, 0
  v_mov_b32 v87, 0
attn_kernel_fbloop:
  ds_read_b128 v[8:11], v2 offset:0
  s_mov_b64 exec, s[28:29]
  ds_read_b128 v[16:19], v3 offset:0
  ds_read_b128 v[20:23], v3 offset:512
  s_mov_b64 exec, -1
  s_waitcnt lgkmcnt(0)
  v_mfma_f32_32x32x16_bf16 v[32:47], v[8:11], v[4:7], 0
  s_nop 15
  s_nop 3
  v_max3_f32 v90, v32, v33, v34
  v_max3_f32 v90, v90, v35, v36
  v_max3_f32 v90, v90, v37, v38
  v_max3_f32 v90, v90, v39, v40
  v_max3_f32 v90, v90, v41, v42
  v_max3_f32 v90, v90, v43, v44
  v_max3_f32 v90, v90, v45, v46
  v_max3_f32 v90, v90, v47, v88
  v_mov_b32 v104, v90
  s_nop 1
  v_permlane32_swap_b32 v90, v104
  s_nop 1
  v_max_f32 v90, v90, v104
  v_sub_f32 v89, v88, v90
  v_exp_f32 v89, v89
  v_mov_b32 v88, v90

  v_sub_f32 v32, v32, v90
  v_sub_f32 v33, v33, v90
  v_sub_f32 v34, v34, v90
  v_sub_f32 v35, v35, v90
  v_sub_f32 v36, v36, v90
  v_sub_f32 v37, v37, v90
  v_sub_f32 v38, v38, v90
  v_sub_f32 v39, v39, v90
  v_sub_f32 v40, v40, v90
  v_sub_f32 v41, v41, v90
  v_sub_f32 v42, v42, v90
  v_sub_f32 v43, v43, v90
  v_sub_f32 v44, v44, v90
  v_sub_f32 v45, v45, v90
  v_sub_f32 v46, v46, v90
  v_sub_f32 v47, v47, v90
  v_exp_f32 v32, v32
  v_exp_f32 v33, v33
  v_exp_f32 v34, v34
  v_exp_f32 v35, v35
  v_exp_f32 v36, v36
  v_exp_f32 v37, v37
  v_exp_f32 v38, v38
  v_exp_f32 v39, v39
  v_exp_f32 v40, v40
  v_exp_f32 v41, v41
  v_exp_f32 v42, v42
  v_exp_f32 v43, v43
  v_exp_f32 v44, v44
  v_exp_f32 v45, v45
  v_exp_f32 v46, v46
  v_exp_f32 v47, v47
  v_mul_f32 v72, v72, v89
  v_mul_f32 v73, v73, v89
  v_mul_f32 v74, v74, v89
  v_mul_f32 v75, v75, v89
  v_mul_f32 v76, v76, v89
  v_mul_f32 v77, v77, v89
  v_mul_f32 v78, v78, v89
  v_mul_f32 v79, v79, v89
  v_mul_f32 v80, v80, v89
  v_mul_f32 v81, v81, v89
  v_mul_f32 v82, v82, v89
  v_mul_f32 v83, v83, v89
  v_mul_f32 v84, v84, v89
  v_mul_f32 v85, v85, v89
  v_mul_f32 v86, v86, v89
  v_mul_f32 v87, v87, v89
  v_cvt_pk_bf16_f32 v64, v32, v33
  v_cvt_pk_bf16_f32 v65, v34, v35
  v_cvt_pk_bf16_f32 v66, v36, v37
  v_cvt_pk_bf16_f32 v67, v38, v39
  v_cvt_pk_bf16_f32 v68, v40, v41
  v_cvt_pk_bf16_f32 v69, v42, v43
  v_cvt_pk_bf16_f32 v70, v44, v45
  v_cvt_pk_bf16_f32 v71, v46, v47
  s_nop 1
  v_mfma_f32_32x32x16_bf16 v[72:87], v[16:19], v[64:67], v[72:87]
  v_mfma_f32_32x32x16_bf16 v[72:87], v[20:23], v[68:71], v[72:87]
  v_add_u32 v2, 1024, v2
  v_add_u32 v3, 1024, v3
  s_nop 15
  s_add_u32 s30, s30, 1
  s_cmp_lt_u32 s30, 64
  s_cbranch_scc1 attn_kernel_fbloop
  s_nop 7
  v_mov_b32 v107, v80
  s_nop 1
  v_permlane32_swap_b32 v80, v107
  s_nop 1
  s_branch attn_kernel_final

attn_kernel_gemm:
  s_setprio 3
  s_sub_u32 s14, s14, 8
  s_and_b32 s12, s15, 3
  s_lshl_b32 s3, s3, 2
  s_add_u32 s12, s12, s3
  s_lshr_b32 s13, s15, 2
  v_lshlrev_b32 v2, 4, v1
  s_mul_i32 s16, s14, 28
  s_lshl_b32 s17, s12, 1
  s_mul_i32 s17, s17, 112
  s_add_u32 s17, s17, s16
  s_lshl_b32 s17, s17, 10
  s_add_u32 s17, s17, 8388608
  s_lshl_b32 s18, s13, 1
  s_mul_i32 s18, s18, 112
  s_add_u32 s18, s18, s16
  s_lshl_b32 s18, s18, 10
  s_add_u32 s18, s18, 23068672
  s_waitcnt lgkmcnt(0)
  s_add_u32 s20, s4, s18
  s_addc_u32 s21, s5, 0
  s_add_u32 s22, s20, 114688
  s_addc_u32 s23, s21, 0
  s_add_u32 s24, s4, s17
  s_addc_u32 s25, s5, 0
  s_add_u32 s26, s24, 114688
  s_addc_u32 s27, s25, 0

  v_mov_b32 v72, 0
  v_mov_b32 v73, 0
  v_mov_b32 v74, 0
  v_mov_b32 v75, 0
  v_mov_b32 v76, 0
  v_mov_b32 v77, 0
  v_mov_b32 v78, 0
  v_mov_b32 v79, 0
  v_mov_b32 v80, 0
  v_mov_b32 v81, 0
  v_mov_b32 v82, 0
  v_mov_b32 v83, 0
  v_mov_b32 v84, 0
  v_mov_b32 v85, 0
  v_mov_b32 v86, 0
  v_mov_b32 v87, 0
  v_mov_b32 v88, 0
  v_mov_b32 v89, 0
  v_mov_b32 v90, 0
  v_mov_b32 v91, 0
  v_mov_b32 v92, 0
  v_mov_b32 v93, 0
  v_mov_b32 v94, 0
  v_mov_b32 v95, 0
  v_mov_b32 v96, 0
  v_mov_b32 v97, 0
  v_mov_b32 v98, 0
  v_mov_b32 v99, 0
  v_mov_b32 v100, 0
  v_mov_b32 v101, 0
  v_mov_b32 v102, 0
  v_mov_b32 v103, 0
  v_mov_b32 v104, 0
  v_mov_b32 v105, 0
  v_mov_b32 v106, 0
  v_mov_b32 v107, 0
  v_mov_b32 v108, 0
  v_mov_b32 v109, 0
  v_mov_b32 v110, 0
  v_mov_b32 v111, 0
  v_mov_b32 v112, 0
  v_mov_b32 v113, 0
  v_mov_b32 v114, 0
  v_mov_b32 v115, 0
  v_mov_b32 v116, 0
  v_mov_b32 v117, 0
  v_mov_b32 v118, 0
  v_mov_b32 v119, 0
  v_mov_b32 v120, 0
  v_mov_b32 v121, 0
  v_mov_b32 v122, 0
  v_mov_b32 v123, 0
  v_mov_b32 v124, 0
  v_mov_b32 v125, 0
  v_mov_b32 v126, 0
  v_mov_b32 v127, 0
  v_mov_b32 v128, 0
  v_mov_b32 v129, 0
  v_mov_b32 v130, 0
  v_mov_b32 v131, 0
  v_mov_b32 v132, 0
  v_mov_b32 v133, 0
  v_mov_b32 v134, 0
  v_mov_b32 v135, 0
  v_mov_b32 v3, 147456
  v_mov_b32 v4, 0
  s_cmp_lg_u32 s14, 0
  s_cbranch_scc1 attn_kernel_g1
  ds_write_b32 v3, v4
  s_waitcnt lgkmcnt(0)
  attn_kernel_g1:
  s_barrier
  s_mov_b32 s30, 0

  global_load_dwordx4 v[8:11], v2, s[20:21] offset:0
  global_load_dwordx4 v[12:15], v2, s[22:23] offset:0
  global_load_dwordx4 v[16:19], v2, s[24:25] offset:0
  global_load_dwordx4 v[20:23], v2, s[26:27] offset:0
  global_load_dwordx4 v[24:27], v2, s[20:21] offset:1024
  global_load_dwordx4 v[28:31], v2, s[22:23] offset:1024
  global_load_dwordx4 v[32:35], v2, s[24:25] offset:1024
  global_load_dwordx4 v[36:39], v2, s[26:27] offset:1024
  global_load_dwordx4 v[40:43], v2, s[20:21] offset:2048
  global_load_dwordx4 v[44:47], v2, s[22:23] offset:2048
  global_load_dwordx4 v[48:51], v2, s[24:25] offset:2048
  global_load_dwordx4 v[52:55], v2, s[26:27] offset:2048
  global_load_dwordx4 v[56:59], v2, s[20:21] offset:3072
  global_load_dwordx4 v[60:63], v2, s[22:23] offset:3072
  global_load_dwordx4 v[64:67], v2, s[24:25] offset:3072
  global_load_dwordx4 v[68:71], v2, s[26:27] offset:3072
  s_add_u32 s20, s20, 4096
  s_addc_u32 s21, s21, 0
  s_add_u32 s22, s22, 4096
  s_addc_u32 s23, s23, 0
  s_add_u32 s24, s24, 4096
  s_addc_u32 s25, s25, 0
  s_add_u32 s26, s26, 4096
  s_addc_u32 s27, s27, 0
attn_kernel_gloop:
  s_waitcnt vmcnt(12)
  v_mfma_f32_32x32x16_bf16 v[72:87], v[8:11], v[16:19], v[72:87]
  v_mfma_f32_32x32x16_bf16 v[88:103], v[8:11], v[20:23], v[88:103]
  v_mfma_f32_32x32x16_bf16 v[104:119], v[12:15], v[16:19], v[104:119]
  v_mfma_f32_32x32x16_bf16 v[120:135], v[12:15], v[20:23], v[120:135]
  global_load_dwordx4 v[8:11], v2, s[20:21] offset:0
  global_load_dwordx4 v[12:15], v2, s[22:23] offset:0
  global_load_dwordx4 v[16:19], v2, s[24:25] offset:0
  global_load_dwordx4 v[20:23], v2, s[26:27] offset:0
  s_waitcnt vmcnt(12)
  v_mfma_f32_32x32x16_bf16 v[72:87], v[24:27], v[32:35], v[72:87]
  v_mfma_f32_32x32x16_bf16 v[88:103], v[24:27], v[36:39], v[88:103]
  v_mfma_f32_32x32x16_bf16 v[104:119], v[28:31], v[32:35], v[104:119]
  v_mfma_f32_32x32x16_bf16 v[120:135], v[28:31], v[36:39], v[120:135]
  global_load_dwordx4 v[24:27], v2, s[20:21] offset:1024
  global_load_dwordx4 v[28:31], v2, s[22:23] offset:1024
  global_load_dwordx4 v[32:35], v2, s[24:25] offset:1024
  global_load_dwordx4 v[36:39], v2, s[26:27] offset:1024
  s_waitcnt vmcnt(12)
  v_mfma_f32_32x32x16_bf16 v[72:87], v[40:43], v[48:51], v[72:87]
  v_mfma_f32_32x32x16_bf16 v[88:103], v[40:43], v[52:55], v[88:103]
  v_mfma_f32_32x32x16_bf16 v[104:119], v[44:47], v[48:51], v[104:119]
  v_mfma_f32_32x32x16_bf16 v[120:135], v[44:47], v[52:55], v[120:135]
  global_load_dwordx4 v[40:43], v2, s[20:21] offset:2048
  global_load_dwordx4 v[44:47], v2, s[22:23] offset:2048
  global_load_dwordx4 v[48:51], v2, s[24:25] offset:2048
  global_load_dwordx4 v[52:55], v2, s[26:27] offset:2048
  s_waitcnt vmcnt(12)
  v_mfma_f32_32x32x16_bf16 v[72:87], v[56:59], v[64:67], v[72:87]
  v_mfma_f32_32x32x16_bf16 v[88:103], v[56:59], v[68:71], v[88:103]
  v_mfma_f32_32x32x16_bf16 v[104:119], v[60:63], v[64:67], v[104:119]
  v_mfma_f32_32x32x16_bf16 v[120:135], v[60:63], v[68:71], v[120:135]
  global_load_dwordx4 v[56:59], v2, s[20:21] offset:3072
  global_load_dwordx4 v[60:63], v2, s[22:23] offset:3072
  global_load_dwordx4 v[64:67], v2, s[24:25] offset:3072
  global_load_dwordx4 v[68:71], v2, s[26:27] offset:3072
  s_add_u32 s20, s20, 4096
  s_addc_u32 s21, s21, 0
  s_add_u32 s22, s22, 4096
  s_addc_u32 s23, s23, 0
  s_add_u32 s24, s24, 4096
  s_addc_u32 s25, s25, 0
  s_add_u32 s26, s26, 4096
  s_addc_u32 s27, s27, 0
  s_cmp_lg_u32 s30, 0
  s_cbranch_scc1 attn_kernel_g2
  s_barrier
  attn_kernel_g2:
  s_add_u32 s30, s30, 1
  s_cmp_lt_u32 s30, 7
  s_cbranch_scc1 attn_kernel_gloop
  s_nop 0
  s_nop 15
  v_add_u32 v5, 131072, v2
  s_cmp_eq_u32 s14, 0
  s_cbranch_scc1 attn_kernel_gw

  attn_kernel_spin:
  ds_read_b32 v4, v3
  s_waitcnt lgkmcnt(0)
  v_readfirstlane_b32 s31, v4
  s_cmp_ge_u32 s31, s14
  s_cbranch_scc1 attn_kernel_go
  s_sleep 4
  s_branch attn_kernel_spin
  attn_kernel_go:

  ds_read_b128 v[136:139], v5 offset:0
  ds_read_b128 v[140:143], v5 offset:1024
  ds_read_b128 v[144:147], v5 offset:2048
  ds_read_b128 v[148:151], v5 offset:3072
  s_waitcnt lgkmcnt(0)
  v_add_f32 v72, v72, v136
  v_add_f32 v73, v73, v137
  v_add_f32 v74, v74, v138
  v_add_f32 v75, v75, v139
  v_add_f32 v76, v76, v140
  v_add_f32 v77, v77, v141
  v_add_f32 v78, v78, v142
  v_add_f32 v79, v79, v143
  v_add_f32 v80, v80, v144
  v_add_f32 v81, v81, v145
  v_add_f32 v82, v82, v146
  v_add_f32 v83, v83, v147
  v_add_f32 v84, v84, v148
  v_add_f32 v85, v85, v149
  v_add_f32 v86, v86, v150
  v_add_f32 v87, v87, v151
  ds_read_b128 v[136:139], v5 offset:4096
  ds_read_b128 v[140:143], v5 offset:5120
  ds_read_b128 v[144:147], v5 offset:6144
  ds_read_b128 v[148:151], v5 offset:7168
  s_waitcnt lgkmcnt(0)
  v_add_f32 v88, v88, v136
  v_add_f32 v89, v89, v137
  v_add_f32 v90, v90, v138
  v_add_f32 v91, v91, v139
  v_add_f32 v92, v92, v140
  v_add_f32 v93, v93, v141
  v_add_f32 v94, v94, v142
  v_add_f32 v95, v95, v143
  v_add_f32 v96, v96, v144
  v_add_f32 v97, v97, v145
  v_add_f32 v98, v98, v146
  v_add_f32 v99, v99, v147
  v_add_f32 v100, v100, v148
  v_add_f32 v101, v101, v149
  v_add_f32 v102, v102, v150
  v_add_f32 v103, v103, v151
  ds_read_b128 v[136:139], v5 offset:8192
  ds_read_b128 v[140:143], v5 offset:9216
  ds_read_b128 v[144:147], v5 offset:10240
  ds_read_b128 v[148:151], v5 offset:11264
  s_waitcnt lgkmcnt(0)
  v_add_f32 v104, v104, v136
  v_add_f32 v105, v105, v137
  v_add_f32 v106, v106, v138
  v_add_f32 v107, v107, v139
  v_add_f32 v108, v108, v140
  v_add_f32 v109, v109, v141
  v_add_f32 v110, v110, v142
  v_add_f32 v111, v111, v143
  v_add_f32 v112, v112, v144
  v_add_f32 v113, v113, v145
  v_add_f32 v114, v114, v146
  v_add_f32 v115, v115, v147
  v_add_f32 v116, v116, v148
  v_add_f32 v117, v117, v149
  v_add_f32 v118, v118, v150
  v_add_f32 v119, v119, v151
  ds_read_b128 v[136:139], v5 offset:12288
  ds_read_b128 v[140:143], v5 offset:13312
  ds_read_b128 v[144:147], v5 offset:14336
  ds_read_b128 v[148:151], v5 offset:15360
  s_waitcnt lgkmcnt(0)
  v_add_f32 v120, v120, v136
  v_add_f32 v121, v121, v137
  v_add_f32 v122, v122, v138
  v_add_f32 v123, v123, v139
  v_add_f32 v124, v124, v140
  v_add_f32 v125, v125, v141
  v_add_f32 v126, v126, v142
  v_add_f32 v127, v127, v143
  v_add_f32 v128, v128, v144
  v_add_f32 v129, v129, v145
  v_add_f32 v130, v130, v146
  v_add_f32 v131, v131, v147
  v_add_f32 v132, v132, v148
  v_add_f32 v133, v133, v149
  v_add_f32 v134, v134, v150
  v_add_f32 v135, v135, v151
  s_cmp_eq_u32 s14, 3
  s_cbranch_scc1 attn_kernel_gfin
  attn_kernel_gw:

  ds_write_b128 v5, v[72:75] offset:0
  ds_write_b128 v5, v[76:79] offset:1024
  ds_write_b128 v5, v[80:83] offset:2048
  ds_write_b128 v5, v[84:87] offset:3072
  ds_write_b128 v5, v[88:91] offset:4096
  ds_write_b128 v5, v[92:95] offset:5120
  ds_write_b128 v5, v[96:99] offset:6144
  ds_write_b128 v5, v[100:103] offset:7168
  ds_write_b128 v5, v[104:107] offset:8192
  ds_write_b128 v5, v[108:111] offset:9216
  ds_write_b128 v5, v[112:115] offset:10240
  ds_write_b128 v5, v[116:119] offset:11264
  ds_write_b128 v5, v[120:123] offset:12288
  ds_write_b128 v5, v[124:127] offset:13312
  ds_write_b128 v5, v[128:131] offset:14336
  ds_write_b128 v5, v[132:135] offset:15360
  s_add_u32 s31, s14, 1
  v_mov_b32 v4, s31
  s_waitcnt lgkmcnt(0)
  ds_write_b32 v3, v4
  s_endpgm
  attn_kernel_gfin:

  s_lshl_b32 s16, s12, 5
  s_lshl_b32 s17, s13, 1
  s_add_u32 s16, s16, s17
  s_lshl_b32 s16, s16, 12
  s_add_u32 s16, s16, 18874368
  s_add_u32 s16, s4, s16
  s_addc_u32 s17, s5, 0
  s_add_u32 s18, s16, 65536
  s_addc_u32 s19, s17, 0
  v_add_u32 v6, 4096, v2

  global_store_dwordx4 v2, v[72:75], s[16:17] offset:0
  global_store_dwordx4 v2, v[76:79], s[16:17] offset:1024
  global_store_dwordx4 v2, v[80:83], s[16:17] offset:2048
  global_store_dwordx4 v2, v[84:87], s[16:17] offset:3072
  global_store_dwordx4 v2, v[88:91], s[18:19] offset:0
  global_store_dwordx4 v2, v[92:95], s[18:19] offset:1024
  global_store_dwordx4 v2, v[96:99], s[18:19] offset:2048
  global_store_dwordx4 v2, v[100:103], s[18:19] offset:3072
  global_store_dwordx4 v6, v[104:107], s[16:17] offset:0
  global_store_dwordx4 v6, v[108:111], s[16:17] offset:1024
  global_store_dwordx4 v6, v[112:115], s[16:17] offset:2048
  global_store_dwordx4 v6, v[116:119], s[16:17] offset:3072
  global_store_dwordx4 v6, v[120:123], s[18:19] offset:0
  global_store_dwordx4 v6, v[124:127], s[18:19] offset:1024
  global_store_dwordx4 v6, v[128:131], s[18:19] offset:2048
  global_store_dwordx4 v6, v[132:135], s[18:19] offset:3072
  s_endpgm
attn_kernel_end:
  s_endpgm
.section .rodata,"a"
.p2align 6
.amdhsa_kernel attn_kernel
  .amdhsa_next_free_vgpr 168
  .amdhsa_next_free_sgpr 102
  .amdhsa_accum_offset 168
  .amdhsa_group_segment_fixed_size 0
  .amdhsa_kernarg_size 80
  .amdhsa_user_sgpr_count 2
  .amdhsa_user_sgpr_kernarg_segment_ptr 1
  .amdhsa_system_sgpr_workgroup_id_x 1
.end_amdhsa_kernel
.text
.globl outp_kernel
.p2align 8
.type outp_kernel,@function
outp_kernel:
  s_cmp_ge_u32 s2, 256
  s_cbranch_scc1 outp_kernel_end
  s_load_dwordx2 s[4:5], s[0:1], 72
  s_load_dwordx2 s[10:11], s[0:1], 0
  s_load_dwordx2 s[44:45], s[0:1], 56
  v_lshrrev_b32 v4, 6, v0
  v_and_b32 v1, 63, v0
  s_and_b32 s3, s2, 7
  v_readfirstlane_b32 s14, v4
  s_lshr_b32 s15, s2, 3
  s_and_b32 s12, s15, 3
  s_lshl_b32 s3, s3, 2
  s_add_u32 s12, s12, s3
  s_lshr_b32 s13, s15, 2
  s_lshl_b32 s12, s12, 1
  s_and_b32 s16, s14, 1
  s_add_u32 s12, s12, s16
  s_lshl_b32 s13, s13, 1
  s_lshr_b32 s16, s14, 1
  s_add_u32 s13, s13, s16
  v_lshlrev_b32 v2, 4, v1
  s_lshl_b32 s16, s12, 15
  s_add_u32 s16, s16, 16777216
  s_lshl_b32 s17, s13, 15
  s_add_u32 s17, s17, 25165824
  s_lshl_b32 s18, s12, 4
  s_add_u32 s18, s18, s13
  s_lshl_b32 s18, s18, 12
  s_add_u32 s18, s18, 18874368
  s_waitcnt lgkmcnt(0)
  s_add_u32 s20, s4, s17
  s_addc_u32 s21, s5, 0
  s_add_u32 s22, s4, s16
  s_addc_u32 s23, s5, 0
  s_add_u32 s24, s4, s18
  s_addc_u32 s25, s5, 0

  global_load_dwordx4 v[20:23], v2, s[22:23] offset:0
  global_load_dwordx4 v[16:19], v2, s[20:21] offset:0
  global_load_dwordx4 v[28:31], v2, s[22:23] offset:1024
  global_load_dwordx4 v[24:27], v2, s[20:21] offset:1024
  global_load_dwordx4 v[36:39], v2, s[22:23] offset:2048
  global_load_dwordx4 v[32:35], v2, s[20:21] offset:2048
  global_load_dwordx4 v[44:47], v2, s[22:23] offset:3072
  global_load_dwordx4 v[40:43], v2, s[20:21] offset:3072
  s_add_u32 s20, s20, 4096
  s_addc_u32 s21, s21, 0
  s_add_u32 s22, s22, 4096
  s_addc_u32 s23, s23, 0
  global_load_dwordx4 v[52:55], v2, s[22:23] offset:0
  global_load_dwordx4 v[48:51], v2, s[20:21] offset:0
  global_load_dwordx4 v[60:63], v2, s[22:23] offset:1024
  global_load_dwordx4 v[56:59], v2, s[20:21] offset:1024
  global_load_dwordx4 v[68:71], v2, s[22:23] offset:2048
  global_load_dwordx4 v[64:67], v2, s[20:21] offset:2048
  global_load_dwordx4 v[76:79], v2, s[22:23] offset:3072
  global_load_dwordx4 v[72:75], v2, s[20:21] offset:3072
  s_add_u32 s20, s20, 4096
  s_addc_u32 s21, s21, 0
  s_add_u32 s22, s22, 4096
  s_addc_u32 s23, s23, 0
  global_load_dwordx4 v[84:87], v2, s[22:23] offset:0
  global_load_dwordx4 v[80:83], v2, s[20:21] offset:0
  global_load_dwordx4 v[92:95], v2, s[22:23] offset:1024
  global_load_dwordx4 v[88:91], v2, s[20:21] offset:1024
  global_load_dwordx4 v[100:103], v2, s[22:23] offset:2048
  global_load_dwordx4 v[96:99], v2, s[20:21] offset:2048
  global_load_dwordx4 v[108:111], v2, s[22:23] offset:3072
  global_load_dwordx4 v[104:107], v2, s[20:21] offset:3072
  s_add_u32 s20, s20, 4096
  s_addc_u32 s21, s21, 0
  s_add_u32 s22, s22, 4096
  s_addc_u32 s23, s23, 0
  global_load_dwordx4 v[116:119], v2, s[22:23] offset:0
  global_load_dwordx4 v[112:115], v2, s[20:21] offset:0
  global_load_dwordx4 v[124:127], v2, s[22:23] offset:1024
  global_load_dwordx4 v[120:123], v2, s[20:21] offset:1024
  global_load_dwordx4 v[132:135], v2, s[22:23] offset:2048
  global_load_dwordx4 v[128:131], v2, s[20:21] offset:2048
  global_load_dwordx4 v[140:143], v2, s[22:23] offset:3072
  global_load_dwordx4 v[136:139], v2, s[20:21] offset:3072
  s_add_u32 s20, s20, 4096
  s_addc_u32 s21, s21, 0
  s_add_u32 s22, s22, 4096
  s_addc_u32 s23, s23, 0
  v_and_b32 v4, 31, v1
  v_lshrrev_b32 v5, 5, v1
  v_lshlrev_b32 v4, 10, v4
  v_lshl_add_u32 v4, v5, 3, v4
  s_lshl_b32 s16, s12, 15
  s_lshl_b32 s17, s13, 6
  s_add_u32 s16, s16, s17
  s_add_u32 s30, s10, s16
  s_addc_u32 s31, s11, 0
  s_add_u32 s32, s44, s16
  s_addc_u32 s33, s45, 0
  s_mov_b32 s40, 0xbfb8aa3b

  s_waitcnt vmcnt(30)
  v_mfma_f32_32x32x16_bf16 v[144:159], v[16:19], v[20:23], 0
  global_load_dwordx4 v[20:23], v2, s[22:23] offset:0
  global_load_dwordx4 v[16:19], v2, s[20:21] offset:0
  s_waitcnt vmcnt(30)
  v_mfma_f32_32x32x16_bf16 v[144:159], v[24:27], v[28:31], v[144:159]
  global_load_dwordx4 v[28:31], v2, s[22:23] offset:1024
  global_load_dwordx4 v[24:27], v2, s[20:21] offset:1024
  s_waitcnt vmcnt(30)
  v_mfma_f32_32x32x16_bf16 v[144:159], v[32:35], v[36:39], v[144:159]
  global_load_dwordx4 v[36:39], v2, s[22:23] offset:2048
  global_load_dwordx4 v[32:35], v2, s[20:21] offset:2048
  s_waitcnt vmcnt(30)
  v_mfma_f32_32x32x16_bf16 v[144:159], v[40:43], v[44:47], v[144:159]
  global_load_dwordx4 v[44:47], v2, s[22:23] offset:3072
  global_load_dwordx4 v[40:43], v2, s[20:21] offset:3072
  s_add_u32 s20, s20, 4096
  s_addc_u32 s21, s21, 0
  s_add_u32 s22, s22, 4096
  s_addc_u32 s23, s23, 0
  s_waitcnt vmcnt(30)
  v_mfma_f32_32x32x16_bf16 v[144:159], v[48:51], v[52:55], v[144:159]
  global_load_dwordx4 v[52:55], v2, s[22:23] offset:0
  global_load_dwordx4 v[48:51], v2, s[20:21] offset:0
  s_waitcnt vmcnt(30)
  v_mfma_f32_32x32x16_bf16 v[144:159], v[56:59], v[60:63], v[144:159]
  global_load_dwordx4 v[60:63], v2, s[22:23] offset:1024
  global_load_dwordx4 v[56:59], v2, s[20:21] offset:1024
  s_waitcnt vmcnt(30)
  v_mfma_f32_32x32x16_bf16 v[144:159], v[64:67], v[68:71], v[144:159]
  global_load_dwordx4 v[68:71], v2, s[22:23] offset:2048
  global_load_dwordx4 v[64:67], v2, s[20:21] offset:2048
  s_waitcnt vmcnt(30)
  v_mfma_f32_32x32x16_bf16 v[144:159], v[72:75], v[76:79], v[144:159]
  global_load_dwordx4 v[76:79], v2, s[22:23] offset:3072
  global_load_dwordx4 v[72:75], v2, s[20:21] offset:3072
  s_add_u32 s20, s20, 4096
  s_addc_u32 s21, s21, 0
  s_add_u32 s22, s22, 4096
  s_addc_u32 s23, s23, 0
  s_waitcnt vmcnt(30)
  v_mfma_f32_32x32x16_bf16 v[144:159], v[80:83], v[84:87], v[144:159]
  global_load_dwordx4 v[84:87], v2, s[22:23] offset:0
  global_load_dwordx4 v[80:83], v2, s[20:21] offset:0
  s_waitcnt vmcnt(30)
  v_mfma_f32_32x32x16_bf16 v[144:159], v[88:91], v[92:95], v[144:159]
  global_load_dwordx4 v[92:95], v2, s[22:23] offset:1024
  global_load_dwordx4 v[88:91], v2, s[20:21] offset:1024
  s_waitcnt vmcnt(30)
  v_mfma_f32_32x32x16_bf16 v[144:159], v[96:99], v[100:103], v[144:159]
  global_load_dwordx4 v[100:103], v2, s[22:23] offset:2048
  global_load_dwordx4 v[96:99], v2, s[20:21] offset:2048
  s_waitcnt vmcnt(30)
  v_mfma_f32_32x32x16_bf16 v[144:159], v[104:107], v[108:111], v[144:159]
  global_load_dwordx4 v[108:111], v2, s[22:23] offset:3072
  global_load_dwordx4 v[104:107], v2, s[20:21] offset:3072
  s_add_u32 s20, s20, 4096
  s_addc_u32 s21, s21, 0
  s_add_u32 s22, s22, 4096
  s_addc_u32 s23, s23, 0
  s_waitcnt vmcnt(30)
  v_mfma_f32_32x32x16_bf16 v[144:159], v[112:115], v[116:119], v[144:159]
  global_load_dwordx4 v[116:119], v2, s[22:23] offset:0
  global_load_dwordx4 v[112:115], v2, s[20:21] offset:0
  s_waitcnt vmcnt(30)
  v_mfma_f32_32x32x16_bf16 v[144:159], v[120:123], v[124:127], v[144:159]
  global_load_dwordx4 v[124:127], v2, s[22:23] offset:1024
  global_load_dwordx4 v[120:123], v2, s[20:21] offset:1024
  s_waitcnt vmcnt(30)
  v_mfma_f32_32x32x16_bf16 v[144:159], v[128:131], v[132:135], v[144:159]
  global_load_dwordx4 v[132:135], v2, s[22:23] offset:2048
  global_load_dwordx4 v[128:131], v2, s[20:21] offset:2048
  s_waitcnt vmcnt(30)
  v_mfma_f32_32x32x16_bf16 v[144:159], v[136:139], v[140:143], v[144:159]
  global_load_dwordx4 v[140:143], v2, s[22:23] offset:3072
  global_load_dwordx4 v[136:139], v2, s[20:21] offset:3072
  s_add_u32 s20, s20, 4096
  s_addc_u32 s21, s21, 0
  s_add_u32 s22, s22, 4096
  s_addc_u32 s23, s23, 0
  global_load_dwordx4 v[160:163], v2, s[24:25] offset:0
  global_load_dwordx4 v[164:167], v2, s[24:25] offset:1024
  global_load_dwordx4 v[168:171], v2, s[24:25] offset:2048
  global_load_dwordx4 v[172:175], v2, s[24:25] offset:3072
  global_load_dwordx2 v[176:177], v4, s[30:31] offset:0
  global_load_dwordx2 v[178:179], v4, s[30:31] offset:16
  global_load_dwordx2 v[180:181], v4, s[30:31] offset:32
  global_load_dwordx2 v[182:183], v4, s[30:31] offset:48
  s_waitcnt vmcnt(38)
  v_mfma_f32_32x32x16_bf16 v[144:159], v[16:19], v[20:23], v[144:159]
  s_waitcnt vmcnt(36)
  v_mfma_f32_32x32x16_bf16 v[144:159], v[24:27], v[28:31], v[144:159]
  s_waitcnt vmcnt(34)
  v_mfma_f32_32x32x16_bf16 v[144:159], v[32:35], v[36:39], v[144:159]
  s_waitcnt vmcnt(32)
  v_mfma_f32_32x32x16_bf16 v[144:159], v[40:43], v[44:47], v[144:159]
  s_waitcnt vmcnt(30)
  v_mfma_f32_32x32x16_bf16 v[144:159], v[48:51], v[52:55], v[144:159]
  s_waitcnt vmcnt(28)
  v_mfma_f32_32x32x16_bf16 v[144:159], v[56:59], v[60:63], v[144:159]
  s_waitcnt vmcnt(26)
  v_mfma_f32_32x32x16_bf16 v[144:159], v[64:67], v[68:71], v[144:159]
  s_waitcnt vmcnt(24)
  v_mfma_f32_32x32x16_bf16 v[144:159], v[72:75], v[76:79], v[144:159]
  s_waitcnt vmcnt(22)
  v_mfma_f32_32x32x16_bf16 v[144:159], v[80:83], v[84:87], v[144:159]
  s_waitcnt vmcnt(20)
  v_mfma_f32_32x32x16_bf16 v[144:159], v[88:91], v[92:95], v[144:159]
  s_waitcnt vmcnt(18)
  v_mfma_f32_32x32x16_bf16 v[144:159], v[96:99], v[100:103], v[144:159]
  s_waitcnt vmcnt(16)
  v_mfma_f32_32x32x16_bf16 v[144:159], v[104:107], v[108:111], v[144:159]
  s_waitcnt vmcnt(14)
  v_mfma_f32_32x32x16_bf16 v[144:159], v[112:115], v[116:119], v[144:159]
  s_waitcnt vmcnt(12)
  v_mfma_f32_32x32x16_bf16 v[144:159], v[120:123], v[124:127], v[144:159]
  s_waitcnt vmcnt(10)
  v_mfma_f32_32x32x16_bf16 v[144:159], v[128:131], v[132:135], v[144:159]
  s_waitcnt vmcnt(8)
  v_mfma_f32_32x32x16_bf16 v[144:159], v[136:139], v[140:143], v[144:159]
  s_waitcnt vmcnt(0)
  v_mul_f32 v16, s40, v160
  v_mul_f32 v17, s40, v161
  v_mul_f32 v18, s40, v162
  v_mul_f32 v19, s40, v163
  v_mul_f32 v20, s40, v164
  v_mul_f32 v21, s40, v165
  v_mul_f32 v22, s40, v166
  v_mul_f32 v23, s40, v167
  v_mul_f32 v24, s40, v168
  v_mul_f32 v25, s40, v169
  v_mul_f32 v26, s40, v170
  v_mul_f32 v27, s40, v171
  v_mul_f32 v28, s40, v172
  v_mul_f32 v29, s40, v173
  v_mul_f32 v30, s40, v174
  v_mul_f32 v31, s40, v175
  v_exp_f32 v16, v16
  v_exp_f32 v17, v17
  v_exp_f32 v18, v18
  v_exp_f32 v19, v19
  v_exp_f32 v20, v20
  v_exp_f32 v21, v21
  v_exp_f32 v22, v22
  v_exp_f32 v23, v23
  v_exp_f32 v24, v24
  v_exp_f32 v25, v25
  v_exp_f32 v26, v26
  v_exp_f32 v27, v27
  v_exp_f32 v28, v28
  v_exp_f32 v29, v29
  v_exp_f32 v30, v30
  v_exp_f32 v31, v31
  v_add_f32 v16, 1.0, v16
  v_add_f32 v17, 1.0, v17
  v_add_f32 v18, 1.0, v18
  v_add_f32 v19, 1.0, v19
  v_add_f32 v20, 1.0, v20
  v_add_f32 v21, 1.0, v21
  v_add_f32 v22, 1.0, v22
  v_add_f32 v23, 1.0, v23
  v_add_f32 v24, 1.0, v24
  v_add_f32 v25, 1.0, v25
  v_add_f32 v26, 1.0, v26
  v_add_f32 v27, 1.0, v27
  v_add_f32 v28, 1.0, v28
  v_add_f32 v29, 1.0, v29
  v_add_f32 v30, 1.0, v30
  v_add_f32 v31, 1.0, v31
  v_rcp_f32 v16, v16
  v_rcp_f32 v17, v17
  v_rcp_f32 v18, v18
  v_rcp_f32 v19, v19
  v_rcp_f32 v20, v20
  v_rcp_f32 v21, v21
  v_rcp_f32 v22, v22
  v_rcp_f32 v23, v23
  v_rcp_f32 v24, v24
  v_rcp_f32 v25, v25
  v_rcp_f32 v26, v26
  v_rcp_f32 v27, v27
  v_rcp_f32 v28, v28
  v_rcp_f32 v29, v29
  v_rcp_f32 v30, v30
  v_rcp_f32 v31, v31
  v_mul_f32 v16, v16, v160
  v_mul_f32 v17, v17, v161
  v_mul_f32 v18, v18, v162
  v_mul_f32 v19, v19, v163
  v_mul_f32 v20, v20, v164
  v_mul_f32 v21, v21, v165
  v_mul_f32 v22, v22, v166
  v_mul_f32 v23, v23, v167
  v_mul_f32 v24, v24, v168
  v_mul_f32 v25, v25, v169
  v_mul_f32 v26, v26, v170
  v_mul_f32 v27, v27, v171
  v_mul_f32 v28, v28, v172
  v_mul_f32 v29, v29, v173
  v_mul_f32 v30, v30, v174
  v_mul_f32 v31, v31, v175
  s_nop 7
  v_mul_f32 v16, v16, v144
  v_mul_f32 v17, v17, v145
  v_mul_f32 v18, v18, v146
  v_mul_f32 v19, v19, v147
  v_lshlrev_b32 v40, 16, v176
  v_and_b32 v41, 0xffff0000, v176
  v_lshlrev_b32 v42, 16, v177
  v_and_b32 v43, 0xffff0000, v177
  v_add_f32 v16, v16, v40
  v_add_f32 v17, v17, v41
  v_add_f32 v18, v18, v42
  v_add_f32 v19, v19, v43
  v_cvt_pk_bf16_f32 v48, v16, v17
  v_cvt_pk_bf16_f32 v49, v18, v19
  global_store_dwordx2 v4, v[48:49], s[32:33] offset:0
  v_mul_f32 v20, v20, v148
  v_mul_f32 v21, v21, v149
  v_mul_f32 v22, v22, v150
  v_mul_f32 v23, v23, v151
  v_lshlrev_b32 v40, 16, v178
  v_and_b32 v41, 0xffff0000, v178
  v_lshlrev_b32 v42, 16, v179
  v_and_b32 v43, 0xffff0000, v179
  v_add_f32 v20, v20, v40
  v_add_f32 v21, v21, v41
  v_add_f32 v22, v22, v42
  v_add_f32 v23, v23, v43
  v_cvt_pk_bf16_f32 v50, v20, v21
  v_cvt_pk_bf16_f32 v51, v22, v23
  global_store_dwordx2 v4, v[50:51], s[32:33] offset:16
  v_mul_f32 v24, v24, v152
  v_mul_f32 v25, v25, v153
  v_mul_f32 v26, v26, v154
  v_mul_f32 v27, v27, v155
  v_lshlrev_b32 v40, 16, v180
  v_and_b32 v41, 0xffff0000, v180
  v_lshlrev_b32 v42, 16, v181
  v_and_b32 v43, 0xffff0000, v181
  v_add_f32 v24, v24, v40
  v_add_f32 v25, v25, v41
  v_add_f32 v26, v26, v42
  v_add_f32 v27, v27, v43
  v_cvt_pk_bf16_f32 v52, v24, v25
  v_cvt_pk_bf16_f32 v53, v26, v27
  global_store_dwordx2 v4, v[52:53], s[32:33] offset:32
  v_mul_f32 v28, v28, v156
  v_mul_f32 v29, v29, v157
  v_mul_f32 v30, v30, v158
  v_mul_f32 v31, v31, v159
  v_lshlrev_b32 v40, 16, v182
  v_and_b32 v41, 0xffff0000, v182
  v_lshlrev_b32 v42, 16, v183
  v_and_b32 v43, 0xffff0000, v183
  v_add_f32 v28, v28, v40
  v_add_f32 v29, v29, v41
  v_add_f32 v30, v30, v42
  v_add_f32 v31, v31, v43
  v_cvt_pk_bf16_f32 v54, v28, v29
  v_cvt_pk_bf16_f32 v55, v30, v31
  global_store_dwordx2 v4, v[54:55], s[32:33] offset:48
outp_kernel_end:
  s_endpgm
.section .rodata,"a"
.p2align 6
.amdhsa_kernel outp_kernel
  .amdhsa_next_free_vgpr 184
  .amdhsa_next_free_sgpr 48
  .amdhsa_accum_offset 184
  .amdhsa_group_segment_fixed_size 0
  .amdhsa_kernarg_size 80
  .amdhsa_user_sgpr_count 2
  .amdhsa_user_sgpr_kernarg_segment_ptr 1
  .amdhsa_system_sgpr_workgroup_id_x 1
.end_amdhsa_kernel
```
